```python
import torch

def _softmax(x, axis=-1):
    return torch.softmax(x, dim=axis)
def _gelu(x):
    return torch.nn.functional.gelu(x, approximate="tanh")
def _silu(x):
    return torch.nn.functional.silu(x)
def _sigmoid(x):
    return torch.sigmoid(x)
def _layernorm(x, axis=-1, eps=1e-5):
    m = x.mean(dim=axis, keepdim=True)
    v = x.var(dim=axis, keepdim=True, unbiased=False)
    return (x - m) / torch.sqrt(v + eps)
def _scatter_add(tgt, idx, src, axis=0):
    return tgt.clone().index_add_(axis, idx, src)
def _segment_sum(src, seg, n):
    out = torch.zeros((n,) + src.shape[1:], dtype=src.dtype)
    return out.index_add_(0, seg, src)
def _pad(x, pw):
    flat = tuple(v for pair in reversed(pw) for v in pair)
    return torch.nn.functional.pad(x, flat)

kernel_name = 'standalone__low_rank_proj_linformer__decode'

def setup_inputs():

    _w = (lambda a: (lambda t: t.to(torch.bfloat16) if t.is_floating_point() else t)(torch.as_tensor(a)))
    B, H, Sq, Skv, Dh, R = 2, 32, 1, 8192, 128, 64
    return {
        "q": _w((lambda *s: torch.randn(*s, dtype=torch.bfloat16) * 0.8)(B, H, Sq, Dh)),
        "k": _w((lambda *s: torch.randn(*s, dtype=torch.bfloat16) * 0.8)(B, H, Skv, Dh)),
        "v": _w((lambda *s: torch.randn(*s, dtype=torch.bfloat16) * 0.05)(B, H, Skv, Dh)),
        "e_proj": _w((lambda *s: torch.randn(*s, dtype=torch.bfloat16) * 0.8)(R, Skv) * (Skv ** -0.5)),
        "f_proj": _w((lambda *s: torch.randn(*s, dtype=torch.bfloat16) * 0.05)(R, Skv) * (Skv ** -0.5)),
    }

def reference(q, k, v, e_proj, f_proj):
    B, H, Sq, Dh = q.shape
    kp = torch.einsum("rn,bhnd->bhrd", e_proj, k)
    vp = torch.einsum("rn,bhnd->bhrd", f_proj, v)
    scores = torch.einsum("bhqd,bhrd->bhqr", q, kp) * (Dh ** -0.5)
    p = _softmax(scores, axis=-1)
    o = torch.einsum("bhqr,bhrd->bhqd", p, vp)
    return o
```

```asm
; @launch grid=(256,1,1) block=(256,1,1) lds=2048
.amdgcn_target "amdgcn-amd-amdhsa--gfx950"
.text
.globl standalone__low_rank_proj_linformer__decode_kernel
.p2align 8
.type standalone__low_rank_proj_linformer__decode_kernel,@function
standalone__low_rank_proj_linformer__decode_kernel:
    s_cmp_ge_u32 s2, 256
    s_cbranch_scc1 L_end
    s_load_dwordx16 s[36:51], s[0:1], 0
    v_and_b32 v1, 63, v0
    v_lshrrev_b32 v12, 6, v0
    v_lshrrev_b32 v2, 4, v1
    v_and_b32 v3, 15, v1
    v_readfirstlane_b32 s56, v12
    v_lshlrev_b32 v9, 4, v3
    v_lshlrev_b32 v4, 11, v2
    v_add_u32 v4, v4, v9
    v_lshlrev_b32 v12, 4, v2
    v_lshlrev_b32 v13, 14, v3
    v_add_u32 v5, v13, v12
    v_add_u32 v6, 0x40000, v5
    v_add_u32 v7, 0x80000, v5
    v_add_u32 v8, 0xc0000, v5
    v_mov_b32 v10, 0
    v_mov_b32 v11, 1
    v_mov_b32 v30, v12
    v_lshlrev_b32 v31, 8, v2
    v_add_u32 v31, v31, v9
    v_lshlrev_b32 v228, 5, v3
    v_add_u32 v228, v228, v12
    v_lshrrev_b32 v229, 5, v1
    v_lshlrev_b32 v229, 9, v229
    v_and_b32 v13, 31, v1
    v_lshlrev_b32 v230, 3, v13
    v_lshlrev_b32 v13, 4, v13
    v_add_u32 v229, v229, v13
    s_and_b32 s73, s56, 0
    s_lshr_b32 s57, s56, 0
    s_lshr_b32 s55, s2, 4
    s_and_b32 s54, s2, 15
    s_mul_i32 s53, s55, 4
    s_add_u32 s53, s53, s57
    s_mul_i32 s75, s54, 1
    s_add_u32 s75, s75, s73
    s_mov_b32 s35, 0x05040100
    s_mov_b32 s52, 0x07060302
    s_lshl_b32 s57, s56, 8
    s_add_u32 s57, s57, 256
    v_add_u32 v28, s57, v9
    v_add_u32 v29, s57, v30
    s_lshl_b32 s66, s53, 12
    s_lshl_b32 s67, s53, 13
    s_add_u32 s67, s67, 262144
    s_add_u32 s68, s67, 4096
    s_lshl_b32 s69, s53, 7
    s_add_u32 s69, s69, 786432
    s_lshl_b32 s70, s55, 4
    s_mov_b32 s71, 0x3e0293ee
    s_lshl_b32 s57, s53, 21
    s_mul_i32 s58, s54, 131072
    s_add_u32 s57, s57, s58
    s_lshl_b32 s58, s73, 13
    s_add_u32 s57, s57, s58
    s_mul_i32 s58, s54, 1024
    s_lshl_b32 s59, s73, 6
    s_add_u32 s58, s58, s59
    s_waitcnt lgkmcnt(0)
    s_add_u32 s4, s38, s57
    s_addc_u32 s5, s39, 0
    s_mov_b32 s6, 0x20000
    s_mov_b32 s7, 0x00020000
    s_add_u32 s12, s40, s57
    s_addc_u32 s13, s41, 0
    s_mov_b32 s14, 0x20000
    s_mov_b32 s15, 0x00020000
    s_sub_u32 s59, 0x100000, s58
    s_add_u32 s8, s42, s58
    s_addc_u32 s9, s43, 0
    s_mov_b32 s10, s59
    s_mov_b32 s11, 0x00020000
    s_add_u32 s16, s44, s58
    s_addc_u32 s17, s45, 0
    s_mov_b32 s18, s59
    s_mov_b32 s19, 0x00020000
    s_mov_b32 s20, s50
    s_mov_b32 s21, s51
    s_mov_b32 s22, 0xc2000
    s_mov_b32 s23, 0x00020000
    s_mov_b32 s24, s48
    s_mov_b32 s25, s49
    s_mov_b32 s26, 0x100
    s_mov_b32 s27, 0x00020000
    s_lshl_b32 s60, s53, 8
    s_add_u32 s28, s46, s60
    s_addc_u32 s29, s47, 0
    s_mov_b32 s30, 0x100
    s_mov_b32 s31, 0x00020000
    s_add_u32 s64, s36, s60
    s_addc_u32 s65, s37, 0
    ds_write_b32 v10, v10
    global_load_dwordx4 v[24:27], v9, s[64:65]
    s_lshr_b32 s78, s2, 4
    s_add_u32 s78, s78, s2
    s_and_b32 s78, s78, 15
    s_mul_i32 s79, s78, 64
    s_mul_i32 s78, s78, 8192
    s_mov_b32 s32, s78
    s_mov_b32 s33, s79
    buffer_load_dwordx4 v[32:35], v4, s[4:7], s32 offen offset:0 nt
    buffer_load_dwordx4 v[36:39], v4, s[4:7], s32 offen offset:256 nt
    buffer_load_dwordx4 v[40:43], v4, s[4:7], s32 offen offset:512 nt
    buffer_load_dwordx4 v[44:47], v4, s[4:7], s32 offen offset:768 nt
    buffer_load_dwordx4 v[48:51], v4, s[4:7], s32 offen offset:1024 nt
    buffer_load_dwordx4 v[52:55], v4, s[4:7], s32 offen offset:1280 nt
    buffer_load_dwordx4 v[56:59], v4, s[4:7], s32 offen offset:1536 nt
    buffer_load_dwordx4 v[60:63], v4, s[4:7], s32 offen offset:1792 nt
    buffer_load_dwordx4 a[128:131], v5, s[8:11], s33 offen
    buffer_load_dwordx4 a[132:135], v6, s[8:11], s33 offen
    buffer_load_dwordx4 a[136:139], v7, s[8:11], s33 offen
    buffer_load_dwordx4 a[140:143], v8, s[8:11], s33 offen
    s_add_u32 s32, s32, 8192
    s_add_u32 s33, s33, 64
    s_and_b32 s32, s32, 0x1ffff
    s_and_b32 s33, s33, 0x3ff
    buffer_load_dwordx4 v[64:67], v4, s[4:7], s32 offen offset:0 nt
    buffer_load_dwordx4 v[68:71], v4, s[4:7], s32 offen offset:256 nt
    buffer_load_dwordx4 v[72:75], v4, s[4:7], s32 offen offset:512 nt
    buffer_load_dwordx4 v[76:79], v4, s[4:7], s32 offen offset:768 nt
    buffer_load_dwordx4 v[80:83], v4, s[4:7], s32 offen offset:1024 nt
    buffer_load_dwordx4 v[84:87], v4, s[4:7], s32 offen offset:1280 nt
    buffer_load_dwordx4 v[88:91], v4, s[4:7], s32 offen offset:1536 nt
    buffer_load_dwordx4 v[92:95], v4, s[4:7], s32 offen offset:1792 nt
    buffer_load_dwordx4 a[144:147], v5, s[8:11], s33 offen
    buffer_load_dwordx4 a[148:151], v6, s[8:11], s33 offen
    buffer_load_dwordx4 a[152:155], v7, s[8:11], s33 offen
    buffer_load_dwordx4 a[156:159], v8, s[8:11], s33 offen
    s_add_u32 s32, s32, 8192
    s_add_u32 s33, s33, 64
    s_and_b32 s32, s32, 0x1ffff
    s_and_b32 s33, s33, 0x3ff
    buffer_load_dwordx4 v[96:99], v4, s[4:7], s32 offen offset:0 nt
    buffer_load_dwordx4 v[100:103], v4, s[4:7], s32 offen offset:256 nt
    buffer_load_dwordx4 v[104:107], v4, s[4:7], s32 offen offset:512 nt
    buffer_load_dwordx4 v[108:111], v4, s[4:7], s32 offen offset:768 nt
    buffer_load_dwordx4 v[112:115], v4, s[4:7], s32 offen offset:1024 nt
    buffer_load_dwordx4 v[116:119], v4, s[4:7], s32 offen offset:1280 nt
    buffer_load_dwordx4 v[120:123], v4, s[4:7], s32 offen offset:1536 nt
    buffer_load_dwordx4 v[124:127], v4, s[4:7], s32 offen offset:1792 nt
    buffer_load_dwordx4 a[160:163], v5, s[8:11], s33 offen
    buffer_load_dwordx4 a[164:167], v6, s[8:11], s33 offen
    buffer_load_dwordx4 a[168:171], v7, s[8:11], s33 offen
    buffer_load_dwordx4 a[172:175], v8, s[8:11], s33 offen
    s_add_u32 s32, s32, 8192
    s_add_u32 s33, s33, 64
    s_and_b32 s32, s32, 0x1ffff
    s_and_b32 s33, s33, 0x3ff
    buffer_load_dwordx4 v[128:131], v4, s[4:7], s32 offen offset:0 nt
    buffer_load_dwordx4 v[132:135], v4, s[4:7], s32 offen offset:256 nt
    buffer_load_dwordx4 v[136:139], v4, s[4:7], s32 offen offset:512 nt
    buffer_load_dwordx4 v[140:143], v4, s[4:7], s32 offen offset:768 nt
    buffer_load_dwordx4 v[144:147], v4, s[4:7], s32 offen offset:1024 nt
    buffer_load_dwordx4 v[148:151], v4, s[4:7], s32 offen offset:1280 nt
    buffer_load_dwordx4 v[152:155], v4, s[4:7], s32 offen offset:1536 nt
    buffer_load_dwordx4 v[156:159], v4, s[4:7], s32 offen offset:1792 nt
    buffer_load_dwordx4 a[176:179], v5, s[8:11], s33 offen
    buffer_load_dwordx4 a[180:183], v6, s[8:11], s33 offen
    buffer_load_dwordx4 a[184:187], v7, s[8:11], s33 offen
    buffer_load_dwordx4 a[188:191], v8, s[8:11], s33 offen
    s_add_u32 s32, s32, 8192
    s_add_u32 s33, s33, 64
    s_and_b32 s32, s32, 0x1ffff
    s_and_b32 s33, s33, 0x3ff
    v_accvgpr_write_b32 a0, 0
    v_accvgpr_write_b32 a1, 0
    v_accvgpr_write_b32 a2, 0
    v_accvgpr_write_b32 a3, 0
    v_accvgpr_write_b32 a4, 0
    v_accvgpr_write_b32 a5, 0
    v_accvgpr_write_b32 a6, 0
    v_accvgpr_write_b32 a7, 0
    v_accvgpr_write_b32 a8, 0
    v_accvgpr_write_b32 a9, 0
    v_accvgpr_write_b32 a10, 0
    v_accvgpr_write_b32 a11, 0
    v_accvgpr_write_b32 a12, 0
    v_accvgpr_write_b32 a13, 0
    v_accvgpr_write_b32 a14, 0
    v_accvgpr_write_b32 a15, 0
    v_accvgpr_write_b32 a16, 0
    v_accvgpr_write_b32 a17, 0
    v_accvgpr_write_b32 a18, 0
    v_accvgpr_write_b32 a19, 0
    v_accvgpr_write_b32 a20, 0
    v_accvgpr_write_b32 a21, 0
    v_accvgpr_write_b32 a22, 0
    v_accvgpr_write_b32 a23, 0
    v_accvgpr_write_b32 a24, 0
    v_accvgpr_write_b32 a25, 0
    v_accvgpr_write_b32 a26, 0
    v_accvgpr_write_b32 a27, 0
    v_accvgpr_write_b32 a28, 0
    v_accvgpr_write_b32 a29, 0
    v_accvgpr_write_b32 a30, 0
    v_accvgpr_write_b32 a31, 0
    v_accvgpr_write_b32 a32, 0
    v_accvgpr_write_b32 a33, 0
    v_accvgpr_write_b32 a34, 0
    v_accvgpr_write_b32 a35, 0
    v_accvgpr_write_b32 a36, 0
    v_accvgpr_write_b32 a37, 0
    v_accvgpr_write_b32 a38, 0
    v_accvgpr_write_b32 a39, 0
    v_accvgpr_write_b32 a40, 0
    v_accvgpr_write_b32 a41, 0
    v_accvgpr_write_b32 a42, 0
    v_accvgpr_write_b32 a43, 0
    v_accvgpr_write_b32 a44, 0
    v_accvgpr_write_b32 a45, 0
    v_accvgpr_write_b32 a46, 0
    v_accvgpr_write_b32 a47, 0
    v_accvgpr_write_b32 a48, 0
    v_accvgpr_write_b32 a49, 0
    v_accvgpr_write_b32 a50, 0
    v_accvgpr_write_b32 a51, 0
    v_accvgpr_write_b32 a52, 0
    v_accvgpr_write_b32 a53, 0
    v_accvgpr_write_b32 a54, 0
    v_accvgpr_write_b32 a55, 0
    v_accvgpr_write_b32 a56, 0
    v_accvgpr_write_b32 a57, 0
    v_accvgpr_write_b32 a58, 0
    v_accvgpr_write_b32 a59, 0
    v_accvgpr_write_b32 a60, 0
    v_accvgpr_write_b32 a61, 0
    v_accvgpr_write_b32 a62, 0
    v_accvgpr_write_b32 a63, 0
    v_accvgpr_write_b32 a64, 0
    v_accvgpr_write_b32 a65, 0
    v_accvgpr_write_b32 a66, 0
    v_accvgpr_write_b32 a67, 0
    v_accvgpr_write_b32 a68, 0
    v_accvgpr_write_b32 a69, 0
    v_accvgpr_write_b32 a70, 0
    v_accvgpr_write_b32 a71, 0
    v_accvgpr_write_b32 a72, 0
    v_accvgpr_write_b32 a73, 0
    v_accvgpr_write_b32 a74, 0
    v_accvgpr_write_b32 a75, 0
    v_accvgpr_write_b32 a76, 0
    v_accvgpr_write_b32 a77, 0
    v_accvgpr_write_b32 a78, 0
    v_accvgpr_write_b32 a79, 0
    v_accvgpr_write_b32 a80, 0
    v_accvgpr_write_b32 a81, 0
    v_accvgpr_write_b32 a82, 0
    v_accvgpr_write_b32 a83, 0
    v_accvgpr_write_b32 a84, 0
    v_accvgpr_write_b32 a85, 0
    v_accvgpr_write_b32 a86, 0
    v_accvgpr_write_b32 a87, 0
    v_accvgpr_write_b32 a88, 0
    v_accvgpr_write_b32 a89, 0
    v_accvgpr_write_b32 a90, 0
    v_accvgpr_write_b32 a91, 0
    v_accvgpr_write_b32 a92, 0
    v_accvgpr_write_b32 a93, 0
    v_accvgpr_write_b32 a94, 0
    v_accvgpr_write_b32 a95, 0
    v_accvgpr_write_b32 a96, 0
    v_accvgpr_write_b32 a97, 0
    v_accvgpr_write_b32 a98, 0
    v_accvgpr_write_b32 a99, 0
    v_accvgpr_write_b32 a100, 0
    v_accvgpr_write_b32 a101, 0
    v_accvgpr_write_b32 a102, 0
    v_accvgpr_write_b32 a103, 0
    v_accvgpr_write_b32 a104, 0
    v_accvgpr_write_b32 a105, 0
    v_accvgpr_write_b32 a106, 0
    v_accvgpr_write_b32 a107, 0
    v_accvgpr_write_b32 a108, 0
    v_accvgpr_write_b32 a109, 0
    v_accvgpr_write_b32 a110, 0
    v_accvgpr_write_b32 a111, 0
    v_accvgpr_write_b32 a112, 0
    v_accvgpr_write_b32 a113, 0
    v_accvgpr_write_b32 a114, 0
    v_accvgpr_write_b32 a115, 0
    v_accvgpr_write_b32 a116, 0
    v_accvgpr_write_b32 a117, 0
    v_accvgpr_write_b32 a118, 0
    v_accvgpr_write_b32 a119, 0
    v_accvgpr_write_b32 a120, 0
    v_accvgpr_write_b32 a121, 0
    v_accvgpr_write_b32 a122, 0
    v_accvgpr_write_b32 a123, 0
    v_accvgpr_write_b32 a124, 0
    v_accvgpr_write_b32 a125, 0
    v_accvgpr_write_b32 a126, 0
    v_accvgpr_write_b32 a127, 0
    s_waitcnt lgkmcnt(0)
    s_barrier
    s_mov_b32 s34, 0
L_loop:
    s_cmp_lg_u32 s34, 3
    s_cbranch_scc1 L_body
    s_mov_b32 s4, s12
    s_mov_b32 s8, s16
    s_mov_b32 s5, s13
    s_mov_b32 s9, s17
    s_mov_b32 s6, s14
    s_mov_b32 s10, s18
    s_mov_b32 s7, s15
    s_mov_b32 s11, s19
    s_mov_b32 s32, s78
    s_mov_b32 s33, s79
L_body:
    s_waitcnt vmcnt(36)
    s_barrier
    v_perm_b32 v160, v36, v32, s35
    v_perm_b32 v161, v44, v40, s35
    v_perm_b32 v162, v52, v48, s35
    v_perm_b32 v163, v60, v56, s35
    v_perm_b32 v164, v36, v32, s52
    v_perm_b32 v165, v44, v40, s52
    v_perm_b32 v166, v52, v48, s52
    v_perm_b32 v167, v60, v56, s52
    v_perm_b32 v168, v37, v33, s35
    v_perm_b32 v169, v45, v41, s35
    v_perm_b32 v170, v53, v49, s35
    v_perm_b32 v171, v61, v57, s35
    v_perm_b32 v172, v37, v33, s52
    v_perm_b32 v173, v45, v41, s52
    v_perm_b32 v174, v53, v49, s52
    v_perm_b32 v175, v61, v57, s52
    v_perm_b32 v176, v38, v34, s35
    v_perm_b32 v177, v46, v42, s35
    v_perm_b32 v178, v54, v50, s35
    v_perm_b32 v179, v62, v58, s35
    v_perm_b32 v180, v38, v34, s52
    v_perm_b32 v181, v46, v42, s52
    v_perm_b32 v182, v54, v50, s52
    v_perm_b32 v183, v62, v58, s52
    v_perm_b32 v184, v39, v35, s35
    v_perm_b32 v185, v47, v43, s35
    v_perm_b32 v186, v55, v51, s35
    v_perm_b32 v187, v63, v59, s35
    v_perm_b32 v188, v39, v35, s52
    v_perm_b32 v189, v47, v43, s52
    v_perm_b32 v190, v55, v51, s52
    v_perm_b32 v191, v63, v59, s52
    buffer_load_dwordx4 v[32:35], v4, s[4:7], s32 offen offset:0 nt
    buffer_load_dwordx4 v[36:39], v4, s[4:7], s32 offen offset:256 nt
    buffer_load_dwordx4 v[40:43], v4, s[4:7], s32 offen offset:512 nt
    buffer_load_dwordx4 v[44:47], v4, s[4:7], s32 offen offset:768 nt
    buffer_load_dwordx4 v[48:51], v4, s[4:7], s32 offen offset:1024 nt
    buffer_load_dwordx4 v[52:55], v4, s[4:7], s32 offen offset:1280 nt
    buffer_load_dwordx4 v[56:59], v4, s[4:7], s32 offen offset:1536 nt
    buffer_load_dwordx4 v[60:63], v4, s[4:7], s32 offen offset:1792 nt
    v_mfma_f32_16x16x32_bf16 a[0:3], a[128:131], v[160:163], a[0:3]
    v_mfma_f32_16x16x32_bf16 a[32:35], a[132:135], v[160:163], a[32:35]
    v_mfma_f32_16x16x32_bf16 a[64:67], a[136:139], v[160:163], a[64:67]
    v_mfma_f32_16x16x32_bf16 a[96:99], a[140:143], v[160:163], a[96:99]
    v_mfma_f32_16x16x32_bf16 a[4:7], a[128:131], v[164:167], a[4:7]
    v_mfma_f32_16x16x32_bf16 a[36:39], a[132:135], v[164:167], a[36:39]
    v_mfma_f32_16x16x32_bf16 a[68:71], a[136:139], v[164:167], a[68:71]
    v_mfma_f32_16x16x32_bf16 a[100:103], a[140:143], v[164:167], a[100:103]
    v_mfma_f32_16x16x32_bf16 a[8:11], a[128:131], v[168:171], a[8:11]
    v_mfma_f32_16x16x32_bf16 a[40:43], a[132:135], v[168:171], a[40:43]
    v_mfma_f32_16x16x32_bf16 a[72:75], a[136:139], v[168:171], a[72:75]
    v_mfma_f32_16x16x32_bf16 a[104:107], a[140:143], v[168:171], a[104:107]
    v_mfma_f32_16x16x32_bf16 a[12:15], a[128:131], v[172:175], a[12:15]
    v_mfma_f32_16x16x32_bf16 a[44:47], a[132:135], v[172:175], a[44:47]
    v_mfma_f32_16x16x32_bf16 a[76:79], a[136:139], v[172:175], a[76:79]
    v_mfma_f32_16x16x32_bf16 a[108:111], a[140:143], v[172:175], a[108:111]
    v_mfma_f32_16x16x32_bf16 a[16:19], a[128:131], v[176:179], a[16:19]
    v_mfma_f32_16x16x32_bf16 a[48:51], a[132:135], v[176:179], a[48:51]
    v_mfma_f32_16x16x32_bf16 a[80:83], a[136:139], v[176:179], a[80:83]
    v_mfma_f32_16x16x32_bf16 a[112:115], a[140:143], v[176:179], a[112:115]
    v_mfma_f32_16x16x32_bf16 a[20:23], a[128:131], v[180:183], a[20:23]
    v_mfma_f32_16x16x32_bf16 a[52:55], a[132:135], v[180:183], a[52:55]
    v_mfma_f32_16x16x32_bf16 a[84:87], a[136:139], v[180:183], a[84:87]
    v_mfma_f32_16x16x32_bf16 a[116:119], a[140:143], v[180:183], a[116:119]
    v_mfma_f32_16x16x32_bf16 a[24:27], a[128:131], v[184:187], a[24:27]
    v_mfma_f32_16x16x32_bf16 a[56:59], a[132:135], v[184:187], a[56:59]
    v_mfma_f32_16x16x32_bf16 a[88:91], a[136:139], v[184:187], a[88:91]
    v_mfma_f32_16x16x32_bf16 a[120:123], a[140:143], v[184:187], a[120:123]
    v_mfma_f32_16x16x32_bf16 a[28:31], a[128:131], v[188:191], a[28:31]
    v_mfma_f32_16x16x32_bf16 a[60:63], a[132:135], v[188:191], a[60:63]
    v_mfma_f32_16x16x32_bf16 a[92:95], a[136:139], v[188:191], a[92:95]
    v_mfma_f32_16x16x32_bf16 a[124:127], a[140:143], v[188:191], a[124:127]
    buffer_load_dwordx4 a[128:131], v5, s[8:11], s33 offen
    buffer_load_dwordx4 a[132:135], v6, s[8:11], s33 offen
    buffer_load_dwordx4 a[136:139], v7, s[8:11], s33 offen
    buffer_load_dwordx4 a[140:143], v8, s[8:11], s33 offen
    s_add_u32 s32, s32, 8192
    s_add_u32 s33, s33, 64
    s_and_b32 s32, s32, 0x1ffff
    s_and_b32 s33, s33, 0x3ff
    s_waitcnt vmcnt(36)
    v_perm_b32 v160, v68, v64, s35
    v_perm_b32 v161, v76, v72, s35
    v_perm_b32 v162, v84, v80, s35
    v_perm_b32 v163, v92, v88, s35
    v_perm_b32 v164, v68, v64, s52
    v_perm_b32 v165, v76, v72, s52
    v_perm_b32 v166, v84, v80, s52
    v_perm_b32 v167, v92, v88, s52
    v_perm_b32 v168, v69, v65, s35
    v_perm_b32 v169, v77, v73, s35
    v_perm_b32 v170, v85, v81, s35
    v_perm_b32 v171, v93, v89, s35
    v_perm_b32 v172, v69, v65, s52
    v_perm_b32 v173, v77, v73, s52
    v_perm_b32 v174, v85, v81, s52
    v_perm_b32 v175, v93, v89, s52
    v_perm_b32 v176, v70, v66, s35
    v_perm_b32 v177, v78, v74, s35
    v_perm_b32 v178, v86, v82, s35
    v_perm_b32 v179, v94, v90, s35
    v_perm_b32 v180, v70, v66, s52
    v_perm_b32 v181, v78, v74, s52
    v_perm_b32 v182, v86, v82, s52
    v_perm_b32 v183, v94, v90, s52
    v_perm_b32 v184, v71, v67, s35
    v_perm_b32 v185, v79, v75, s35
    v_perm_b32 v186, v87, v83, s35
    v_perm_b32 v187, v95, v91, s35
    v_perm_b32 v188, v71, v67, s52
    v_perm_b32 v189, v79, v75, s52
    v_perm_b32 v190, v87, v83, s52
    v_perm_b32 v191, v95, v91, s52
    buffer_load_dwordx4 v[64:67], v4, s[4:7], s32 offen offset:0 nt
    buffer_load_dwordx4 v[68:71], v4, s[4:7], s32 offen offset:256 nt
    buffer_load_dwordx4 v[72:75], v4, s[4:7], s32 offen offset:512 nt
    buffer_load_dwordx4 v[76:79], v4, s[4:7], s32 offen offset:768 nt
    buffer_load_dwordx4 v[80:83], v4, s[4:7], s32 offen offset:1024 nt
    buffer_load_dwordx4 v[84:87], v4, s[4:7], s32 offen offset:1280 nt
    buffer_load_dwordx4 v[88:91], v4, s[4:7], s32 offen offset:1536 nt
    buffer_load_dwordx4 v[92:95], v4, s[4:7], s32 offen offset:1792 nt
    v_mfma_f32_16x16x32_bf16 a[0:3], a[144:147], v[160:163], a[0:3]
    v_mfma_f32_16x16x32_bf16 a[32:35], a[148:151], v[160:163], a[32:35]
    v_mfma_f32_16x16x32_bf16 a[64:67], a[152:155], v[160:163], a[64:67]
    v_mfma_f32_16x16x32_bf16 a[96:99], a[156:159], v[160:163], a[96:99]
    v_mfma_f32_16x16x32_bf16 a[4:7], a[144:147], v[164:167], a[4:7]
    v_mfma_f32_16x16x32_bf16 a[36:39], a[148:151], v[164:167], a[36:39]
    v_mfma_f32_16x16x32_bf16 a[68:71], a[152:155], v[164:167], a[68:71]
    v_mfma_f32_16x16x32_bf16 a[100:103], a[156:159], v[164:167], a[100:103]
    v_mfma_f32_16x16x32_bf16 a[8:11], a[144:147], v[168:171], a[8:11]
    v_mfma_f32_16x16x32_bf16 a[40:43], a[148:151], v[168:171], a[40:43]
    v_mfma_f32_16x16x32_bf16 a[72:75], a[152:155], v[168:171], a[72:75]
    v_mfma_f32_16x16x32_bf16 a[104:107], a[156:159], v[168:171], a[104:107]
    v_mfma_f32_16x16x32_bf16 a[12:15], a[144:147], v[172:175], a[12:15]
    v_mfma_f32_16x16x32_bf16 a[44:47], a[148:151], v[172:175], a[44:47]
    v_mfma_f32_16x16x32_bf16 a[76:79], a[152:155], v[172:175], a[76:79]
    v_mfma_f32_16x16x32_bf16 a[108:111], a[156:159], v[172:175], a[108:111]
    v_mfma_f32_16x16x32_bf16 a[16:19], a[144:147], v[176:179], a[16:19]
    v_mfma_f32_16x16x32_bf16 a[48:51], a[148:151], v[176:179], a[48:51]
    v_mfma_f32_16x16x32_bf16 a[80:83], a[152:155], v[176:179], a[80:83]
    v_mfma_f32_16x16x32_bf16 a[112:115], a[156:159], v[176:179], a[112:115]
    v_mfma_f32_16x16x32_bf16 a[20:23], a[144:147], v[180:183], a[20:23]
    v_mfma_f32_16x16x32_bf16 a[52:55], a[148:151], v[180:183], a[52:55]
    v_mfma_f32_16x16x32_bf16 a[84:87], a[152:155], v[180:183], a[84:87]
    v_mfma_f32_16x16x32_bf16 a[116:119], a[156:159], v[180:183], a[116:119]
    v_mfma_f32_16x16x32_bf16 a[24:27], a[144:147], v[184:187], a[24:27]
    v_mfma_f32_16x16x32_bf16 a[56:59], a[148:151], v[184:187], a[56:59]
    v_mfma_f32_16x16x32_bf16 a[88:91], a[152:155], v[184:187], a[88:91]
    v_mfma_f32_16x16x32_bf16 a[120:123], a[156:159], v[184:187], a[120:123]
    v_mfma_f32_16x16x32_bf16 a[28:31], a[144:147], v[188:191], a[28:31]
    v_mfma_f32_16x16x32_bf16 a[60:63], a[148:151], v[188:191], a[60:63]
    v_mfma_f32_16x16x32_bf16 a[92:95], a[152:155], v[188:191], a[92:95]
    v_mfma_f32_16x16x32_bf16 a[124:127], a[156:159], v[188:191], a[124:127]
    buffer_load_dwordx4 a[144:147], v5, s[8:11], s33 offen
    buffer_load_dwordx4 a[148:151], v6, s[8:11], s33 offen
    buffer_load_dwordx4 a[152:155], v7, s[8:11], s33 offen
    buffer_load_dwordx4 a[156:159], v8, s[8:11], s33 offen
    s_add_u32 s32, s32, 8192
    s_add_u32 s33, s33, 64
    s_and_b32 s32, s32, 0x1ffff
    s_and_b32 s33, s33, 0x3ff
    s_waitcnt vmcnt(36)
    v_perm_b32 v160, v100, v96, s35
    v_perm_b32 v161, v108, v104, s35
    v_perm_b32 v162, v116, v112, s35
    v_perm_b32 v163, v124, v120, s35
    v_perm_b32 v164, v100, v96, s52
    v_perm_b32 v165, v108, v104, s52
    v_perm_b32 v166, v116, v112, s52
    v_perm_b32 v167, v124, v120, s52
    v_perm_b32 v168, v101, v97, s35
    v_perm_b32 v169, v109, v105, s35
    v_perm_b32 v170, v117, v113, s35
    v_perm_b32 v171, v125, v121, s35
    v_perm_b32 v172, v101, v97, s52
    v_perm_b32 v173, v109, v105, s52
    v_perm_b32 v174, v117, v113, s52
    v_perm_b32 v175, v125, v121, s52
    v_perm_b32 v176, v102, v98, s35
    v_perm_b32 v177, v110, v106, s35
    v_perm_b32 v178, v118, v114, s35
    v_perm_b32 v179, v126, v122, s35
    v_perm_b32 v180, v102, v98, s52
    v_perm_b32 v181, v110, v106, s52
    v_perm_b32 v182, v118, v114, s52
    v_perm_b32 v183, v126, v122, s52
    v_perm_b32 v184, v103, v99, s35
    v_perm_b32 v185, v111, v107, s35
    v_perm_b32 v186, v119, v115, s35
    v_perm_b32 v187, v127, v123, s35
    v_perm_b32 v188, v103, v99, s52
    v_perm_b32 v189, v111, v107, s52
    v_perm_b32 v190, v119, v115, s52
    v_perm_b32 v191, v127, v123, s52
    buffer_load_dwordx4 v[96:99], v4, s[4:7], s32 offen offset:0 nt
    buffer_load_dwordx4 v[100:103], v4, s[4:7], s32 offen offset:256 nt
    buffer_load_dwordx4 v[104:107], v4, s[4:7], s32 offen offset:512 nt
    buffer_load_dwordx4 v[108:111], v4, s[4:7], s32 offen offset:768 nt
    buffer_load_dwordx4 v[112:115], v4, s[4:7], s32 offen offset:1024 nt
    buffer_load_dwordx4 v[116:119], v4, s[4:7], s32 offen offset:1280 nt
    buffer_load_dwordx4 v[120:123], v4, s[4:7], s32 offen offset:1536 nt
    buffer_load_dwordx4 v[124:127], v4, s[4:7], s32 offen offset:1792 nt
    v_mfma_f32_16x16x32_bf16 a[0:3], a[160:163], v[160:163], a[0:3]
    v_mfma_f32_16x16x32_bf16 a[32:35], a[164:167], v[160:163], a[32:35]
    v_mfma_f32_16x16x32_bf16 a[64:67], a[168:171], v[160:163], a[64:67]
    v_mfma_f32_16x16x32_bf16 a[96:99], a[172:175], v[160:163], a[96:99]
    v_mfma_f32_16x16x32_bf16 a[4:7], a[160:163], v[164:167], a[4:7]
    v_mfma_f32_16x16x32_bf16 a[36:39], a[164:167], v[164:167], a[36:39]
    v_mfma_f32_16x16x32_bf16 a[68:71], a[168:171], v[164:167], a[68:71]
    v_mfma_f32_16x16x32_bf16 a[100:103], a[172:175], v[164:167], a[100:103]
    v_mfma_f32_16x16x32_bf16 a[8:11], a[160:163], v[168:171], a[8:11]
    v_mfma_f32_16x16x32_bf16 a[40:43], a[164:167], v[168:171], a[40:43]
    v_mfma_f32_16x16x32_bf16 a[72:75], a[168:171], v[168:171], a[72:75]
    v_mfma_f32_16x16x32_bf16 a[104:107], a[172:175], v[168:171], a[104:107]
    v_mfma_f32_16x16x32_bf16 a[12:15], a[160:163], v[172:175], a[12:15]
    v_mfma_f32_16x16x32_bf16 a[44:47], a[164:167], v[172:175], a[44:47]
    v_mfma_f32_16x16x32_bf16 a[76:79], a[168:171], v[172:175], a[76:79]
    v_mfma_f32_16x16x32_bf16 a[108:111], a[172:175], v[172:175], a[108:111]
    v_mfma_f32_16x16x32_bf16 a[16:19], a[160:163], v[176:179], a[16:19]
    v_mfma_f32_16x16x32_bf16 a[48:51], a[164:167], v[176:179], a[48:51]
    v_mfma_f32_16x16x32_bf16 a[80:83], a[168:171], v[176:179], a[80:83]
    v_mfma_f32_16x16x32_bf16 a[112:115], a[172:175], v[176:179], a[112:115]
    v_mfma_f32_16x16x32_bf16 a[20:23], a[160:163], v[180:183], a[20:23]
    v_mfma_f32_16x16x32_bf16 a[52:55], a[164:167], v[180:183], a[52:55]
    v_mfma_f32_16x16x32_bf16 a[84:87], a[168:171], v[180:183], a[84:87]
    v_mfma_f32_16x16x32_bf16 a[116:119], a[172:175], v[180:183], a[116:119]
    v_mfma_f32_16x16x32_bf16 a[24:27], a[160:163], v[184:187], a[24:27]
    v_mfma_f32_16x16x32_bf16 a[56:59], a[164:167], v[184:187], a[56:59]
    v_mfma_f32_16x16x32_bf16 a[88:91], a[168:171], v[184:187], a[88:91]
    v_mfma_f32_16x16x32_bf16 a[120:123], a[172:175], v[184:187], a[120:123]
    v_mfma_f32_16x16x32_bf16 a[28:31], a[160:163], v[188:191], a[28:31]
    v_mfma_f32_16x16x32_bf16 a[60:63], a[164:167], v[188:191], a[60:63]
    v_mfma_f32_16x16x32_bf16 a[92:95], a[168:171], v[188:191], a[92:95]
    v_mfma_f32_16x16x32_bf16 a[124:127], a[172:175], v[188:191], a[124:127]
    buffer_load_dwordx4 a[160:163], v5, s[8:11], s33 offen
    buffer_load_dwordx4 a[164:167], v6, s[8:11], s33 offen
    buffer_load_dwordx4 a[168:171], v7, s[8:11], s33 offen
    buffer_load_dwordx4 a[172:175], v8, s[8:11], s33 offen
    s_add_u32 s32, s32, 8192
    s_add_u32 s33, s33, 64
    s_and_b32 s32, s32, 0x1ffff
    s_and_b32 s33, s33, 0x3ff
    s_waitcnt vmcnt(36)
    v_perm_b32 v160, v132, v128, s35
    v_perm_b32 v161, v140, v136, s35
    v_perm_b32 v162, v148, v144, s35
    v_perm_b32 v163, v156, v152, s35
    v_perm_b32 v164, v132, v128, s52
    v_perm_b32 v165, v140, v136, s52
    v_perm_b32 v166, v148, v144, s52
    v_perm_b32 v167, v156, v152, s52
    v_perm_b32 v168, v133, v129, s35
    v_perm_b32 v169, v141, v137, s35
    v_perm_b32 v170, v149, v145, s35
    v_perm_b32 v171, v157, v153, s35
    v_perm_b32 v172, v133, v129, s52
    v_perm_b32 v173, v141, v137, s52
    v_perm_b32 v174, v149, v145, s52
    v_perm_b32 v175, v157, v153, s52
    v_perm_b32 v176, v134, v130, s35
    v_perm_b32 v177, v142, v138, s35
    v_perm_b32 v178, v150, v146, s35
    v_perm_b32 v179, v158, v154, s35
    v_perm_b32 v180, v134, v130, s52
    v_perm_b32 v181, v142, v138, s52
    v_perm_b32 v182, v150, v146, s52
    v_perm_b32 v183, v158, v154, s52
    v_perm_b32 v184, v135, v131, s35
    v_perm_b32 v185, v143, v139, s35
    v_perm_b32 v186, v151, v147, s35
    v_perm_b32 v187, v159, v155, s35
    v_perm_b32 v188, v135, v131, s52
    v_perm_b32 v189, v143, v139, s52
    v_perm_b32 v190, v151, v147, s52
    v_perm_b32 v191, v159, v155, s52
    buffer_load_dwordx4 v[128:131], v4, s[4:7], s32 offen offset:0 nt
    buffer_load_dwordx4 v[132:135], v4, s[4:7], s32 offen offset:256 nt
    buffer_load_dwordx4 v[136:139], v4, s[4:7], s32 offen offset:512 nt
    buffer_load_dwordx4 v[140:143], v4, s[4:7], s32 offen offset:768 nt
    buffer_load_dwordx4 v[144:147], v4, s[4:7], s32 offen offset:1024 nt
    buffer_load_dwordx4 v[148:151], v4, s[4:7], s32 offen offset:1280 nt
    buffer_load_dwordx4 v[152:155], v4, s[4:7], s32 offen offset:1536 nt
    buffer_load_dwordx4 v[156:159], v4, s[4:7], s32 offen offset:1792 nt
    v_mfma_f32_16x16x32_bf16 a[0:3], a[176:179], v[160:163], a[0:3]
    v_mfma_f32_16x16x32_bf16 a[32:35], a[180:183], v[160:163], a[32:35]
    v_mfma_f32_16x16x32_bf16 a[64:67], a[184:187], v[160:163], a[64:67]
    v_mfma_f32_16x16x32_bf16 a[96:99], a[188:191], v[160:163], a[96:99]
    v_mfma_f32_16x16x32_bf16 a[4:7], a[176:179], v[164:167], a[4:7]
    v_mfma_f32_16x16x32_bf16 a[36:39], a[180:183], v[164:167], a[36:39]
    v_mfma_f32_16x16x32_bf16 a[68:71], a[184:187], v[164:167], a[68:71]
    v_mfma_f32_16x16x32_bf16 a[100:103], a[188:191], v[164:167], a[100:103]
    v_mfma_f32_16x16x32_bf16 a[8:11], a[176:179], v[168:171], a[8:11]
    v_mfma_f32_16x16x32_bf16 a[40:43], a[180:183], v[168:171], a[40:43]
    v_mfma_f32_16x16x32_bf16 a[72:75], a[184:187], v[168:171], a[72:75]
    v_mfma_f32_16x16x32_bf16 a[104:107], a[188:191], v[168:171], a[104:107]
    v_mfma_f32_16x16x32_bf16 a[12:15], a[176:179], v[172:175], a[12:15]
    v_mfma_f32_16x16x32_bf16 a[44:47], a[180:183], v[172:175], a[44:47]
    v_mfma_f32_16x16x32_bf16 a[76:79], a[184:187], v[172:175], a[76:79]
    v_mfma_f32_16x16x32_bf16 a[108:111], a[188:191], v[172:175], a[108:111]
    v_mfma_f32_16x16x32_bf16 a[16:19], a[176:179], v[176:179], a[16:19]
    v_mfma_f32_16x16x32_bf16 a[48:51], a[180:183], v[176:179], a[48:51]
    v_mfma_f32_16x16x32_bf16 a[80:83], a[184:187], v[176:179], a[80:83]
    v_mfma_f32_16x16x32_bf16 a[112:115], a[188:191], v[176:179], a[112:115]
    v_mfma_f32_16x16x32_bf16 a[20:23], a[176:179], v[180:183], a[20:23]
    v_mfma_f32_16x16x32_bf16 a[52:55], a[180:183], v[180:183], a[52:55]
    v_mfma_f32_16x16x32_bf16 a[84:87], a[184:187], v[180:183], a[84:87]
    v_mfma_f32_16x16x32_bf16 a[116:119], a[188:191], v[180:183], a[116:119]
    v_mfma_f32_16x16x32_bf16 a[24:27], a[176:179], v[184:187], a[24:27]
    v_mfma_f32_16x16x32_bf16 a[56:59], a[180:183], v[184:187], a[56:59]
    v_mfma_f32_16x16x32_bf16 a[88:91], a[184:187], v[184:187], a[88:91]
    v_mfma_f32_16x16x32_bf16 a[120:123], a[188:191], v[184:187], a[120:123]
    v_mfma_f32_16x16x32_bf16 a[28:31], a[176:179], v[188:191], a[28:31]
    v_mfma_f32_16x16x32_bf16 a[60:63], a[180:183], v[188:191], a[60:63]
    v_mfma_f32_16x16x32_bf16 a[92:95], a[184:187], v[188:191], a[92:95]
    v_mfma_f32_16x16x32_bf16 a[124:127], a[188:191], v[188:191], a[124:127]
    buffer_load_dwordx4 a[176:179], v5, s[8:11], s33 offen
    buffer_load_dwordx4 a[180:183], v6, s[8:11], s33 offen
    buffer_load_dwordx4 a[184:187], v7, s[8:11], s33 offen
    buffer_load_dwordx4 a[188:191], v8, s[8:11], s33 offen
    s_add_u32 s32, s32, 8192
    s_add_u32 s33, s33, 64
    s_and_b32 s32, s32, 0x1ffff
    s_and_b32 s33, s33, 0x3ff
    s_add_u32 s34, s34, 1
    s_cmp_eq_u32 s34, 4
    s_cbranch_scc1 L_kepi
    s_cmp_eq_u32 s34, 5
    s_cbranch_scc1 L_publish
    s_cmp_eq_u32 s34, 6
    s_cbranch_scc1 L_poll
    s_cmp_lt_u32 s34, 7
    s_cbranch_scc1 L_loop
    s_branch L_last
L_kepi:
    s_nop 7
    s_nop 7
    v_lshlrev_b32 v16, 16, v24
    v_and_b32 v17, 0xffff0000, v24
    v_lshlrev_b32 v18, 16, v25
    v_and_b32 v19, 0xffff0000, v25
    v_lshlrev_b32 v20, 16, v26
    v_and_b32 v21, 0xffff0000, v26
    v_lshlrev_b32 v22, 16, v27
    v_and_b32 v23, 0xffff0000, v27
    v_accvgpr_read_b32 v176, a0
    v_accvgpr_read_b32 v177, a1
    v_accvgpr_read_b32 v178, a2
    v_accvgpr_read_b32 v179, a3
    v_accvgpr_write_b32 a0, 0
    v_accvgpr_write_b32 a1, 0
    v_accvgpr_write_b32 a2, 0
    v_accvgpr_write_b32 a3, 0
    v_mul_f32 v160, v176, v16
    v_mul_f32 v161, v177, v16
    v_mul_f32 v162, v178, v16
    v_mul_f32 v163, v179, v16
    v_accvgpr_read_b32 v176, a4
    v_accvgpr_read_b32 v177, a5
    v_accvgpr_read_b32 v178, a6
    v_accvgpr_read_b32 v179, a7
    v_accvgpr_write_b32 a4, 0
    v_accvgpr_write_b32 a5, 0
    v_accvgpr_write_b32 a6, 0
    v_accvgpr_write_b32 a7, 0
    v_fmac_f32 v160, v176, v17
    v_fmac_f32 v161, v177, v17
    v_fmac_f32 v162, v178, v17
    v_fmac_f32 v163, v179, v17
    v_accvgpr_read_b32 v176, a8
    v_accvgpr_read_b32 v177, a9
    v_accvgpr_read_b32 v178, a10
    v_accvgpr_read_b32 v179, a11
    v_accvgpr_write_b32 a8, 0
    v_accvgpr_write_b32 a9, 0
    v_accvgpr_write_b32 a10, 0
    v_accvgpr_write_b32 a11, 0
    v_fmac_f32 v160, v176, v18
    v_fmac_f32 v161, v177, v18
    v_fmac_f32 v162, v178, v18
    v_fmac_f32 v163, v179, v18
    v_accvgpr_read_b32 v176, a12
    v_accvgpr_read_b32 v177, a13
    v_accvgpr_read_b32 v178, a14
    v_accvgpr_read_b32 v179, a15
    v_accvgpr_write_b32 a12, 0
    v_accvgpr_write_b32 a13, 0
    v_accvgpr_write_b32 a14, 0
    v_accvgpr_write_b32 a15, 0
    v_fmac_f32 v160, v176, v19
    v_fmac_f32 v161, v177, v19
    v_fmac_f32 v162, v178, v19
    v_fmac_f32 v163, v179, v19
    v_accvgpr_read_b32 v176, a16
    v_accvgpr_read_b32 v177, a17
    v_accvgpr_read_b32 v178, a18
    v_accvgpr_read_b32 v179, a19
    v_accvgpr_write_b32 a16, 0
    v_accvgpr_write_b32 a17, 0
    v_accvgpr_write_b32 a18, 0
    v_accvgpr_write_b32 a19, 0
    v_fmac_f32 v160, v176, v20
    v_fmac_f32 v161, v177, v20
    v_fmac_f32 v162, v178, v20
    v_fmac_f32 v163, v179, v20
    v_accvgpr_read_b32 v176, a20
    v_accvgpr_read_b32 v177, a21
    v_accvgpr_read_b32 v178, a22
    v_accvgpr_read_b32 v179, a23
    v_accvgpr_write_b32 a20, 0
    v_accvgpr_write_b32 a21, 0
    v_accvgpr_write_b32 a22, 0
    v_accvgpr_write_b32 a23, 0
    v_fmac_f32 v160, v176, v21
    v_fmac_f32 v161, v177, v21
    v_fmac_f32 v162, v178, v21
    v_fmac_f32 v163, v179, v21
    v_accvgpr_read_b32 v176, a24
    v_accvgpr_read_b32 v177, a25
    v_accvgpr_read_b32 v178, a26
    v_accvgpr_read_b32 v179, a27
    v_accvgpr_write_b32 a24, 0
    v_accvgpr_write_b32 a25, 0
    v_accvgpr_write_b32 a26, 0
    v_accvgpr_write_b32 a27, 0
    v_fmac_f32 v160, v176, v22
    v_fmac_f32 v161, v177, v22
    v_fmac_f32 v162, v178, v22
    v_fmac_f32 v163, v179, v22
    v_accvgpr_read_b32 v176, a28
    v_accvgpr_read_b32 v177, a29
    v_accvgpr_read_b32 v178, a30
    v_accvgpr_read_b32 v179, a31
    v_accvgpr_write_b32 a28, 0
    v_accvgpr_write_b32 a29, 0
    v_accvgpr_write_b32 a30, 0
    v_accvgpr_write_b32 a31, 0
    v_fmac_f32 v160, v176, v23
    v_fmac_f32 v161, v177, v23
    v_fmac_f32 v162, v178, v23
    v_fmac_f32 v163, v179, v23
    v_accvgpr_read_b32 v176, a32
    v_accvgpr_read_b32 v177, a33
    v_accvgpr_read_b32 v178, a34
    v_accvgpr_read_b32 v179, a35
    v_accvgpr_write_b32 a32, 0
    v_accvgpr_write_b32 a33, 0
    v_accvgpr_write_b32 a34, 0
    v_accvgpr_write_b32 a35, 0
    v_mul_f32 v164, v176, v16
    v_mul_f32 v165, v177, v16
    v_mul_f32 v166, v178, v16
    v_mul_f32 v167, v179, v16
    v_accvgpr_read_b32 v176, a36
    v_accvgpr_read_b32 v177, a37
    v_accvgpr_read_b32 v178, a38
    v_accvgpr_read_b32 v179, a39
    v_accvgpr_write_b32 a36, 0
    v_accvgpr_write_b32 a37, 0
    v_accvgpr_write_b32 a38, 0
    v_accvgpr_write_b32 a39, 0
    v_fmac_f32 v164, v176, v17
    v_fmac_f32 v165, v177, v17
    v_fmac_f32 v166, v178, v17
    v_fmac_f32 v167, v179, v17
    v_accvgpr_read_b32 v176, a40
    v_accvgpr_read_b32 v177, a41
    v_accvgpr_read_b32 v178, a42
    v_accvgpr_read_b32 v179, a43
    v_accvgpr_write_b32 a40, 0
    v_accvgpr_write_b32 a41, 0
    v_accvgpr_write_b32 a42, 0
    v_accvgpr_write_b32 a43, 0
    v_fmac_f32 v164, v176, v18
    v_fmac_f32 v165, v177, v18
    v_fmac_f32 v166, v178, v18
    v_fmac_f32 v167, v179, v18
    v_accvgpr_read_b32 v176, a44
    v_accvgpr_read_b32 v177, a45
    v_accvgpr_read_b32 v178, a46
    v_accvgpr_read_b32 v179, a47
    v_accvgpr_write_b32 a44, 0
    v_accvgpr_write_b32 a45, 0
    v_accvgpr_write_b32 a46, 0
    v_accvgpr_write_b32 a47, 0
    v_fmac_f32 v164, v176, v19
    v_fmac_f32 v165, v177, v19
    v_fmac_f32 v166, v178, v19
    v_fmac_f32 v167, v179, v19
    v_accvgpr_read_b32 v176, a48
    v_accvgpr_read_b32 v177, a49
    v_accvgpr_read_b32 v178, a50
    v_accvgpr_read_b32 v179, a51
    v_accvgpr_write_b32 a48, 0
    v_accvgpr_write_b32 a49, 0
    v_accvgpr_write_b32 a50, 0
    v_accvgpr_write_b32 a51, 0
    v_fmac_f32 v164, v176, v20
    v_fmac_f32 v165, v177, v20
    v_fmac_f32 v166, v178, v20
    v_fmac_f32 v167, v179, v20
    v_accvgpr_read_b32 v176, a52
    v_accvgpr_read_b32 v177, a53
    v_accvgpr_read_b32 v178, a54
    v_accvgpr_read_b32 v179, a55
    v_accvgpr_write_b32 a52, 0
    v_accvgpr_write_b32 a53, 0
    v_accvgpr_write_b32 a54, 0
    v_accvgpr_write_b32 a55, 0
    v_fmac_f32 v164, v176, v21
    v_fmac_f32 v165, v177, v21
    v_fmac_f32 v166, v178, v21
    v_fmac_f32 v167, v179, v21
    v_accvgpr_read_b32 v176, a56
    v_accvgpr_read_b32 v177, a57
    v_accvgpr_read_b32 v178, a58
    v_accvgpr_read_b32 v179, a59
    v_accvgpr_write_b32 a56, 0
    v_accvgpr_write_b32 a57, 0
    v_accvgpr_write_b32 a58, 0
    v_accvgpr_write_b32 a59, 0
    v_fmac_f32 v164, v176, v22
    v_fmac_f32 v165, v177, v22
    v_fmac_f32 v166, v178, v22
    v_fmac_f32 v167, v179, v22
    v_accvgpr_read_b32 v176, a60
    v_accvgpr_read_b32 v177, a61
    v_accvgpr_read_b32 v178, a62
    v_accvgpr_read_b32 v179, a63
    v_accvgpr_write_b32 a60, 0
    v_accvgpr_write_b32 a61, 0
    v_accvgpr_write_b32 a62, 0
    v_accvgpr_write_b32 a63, 0
    v_fmac_f32 v164, v176, v23
    v_fmac_f32 v165, v177, v23
    v_fmac_f32 v166, v178, v23
    v_fmac_f32 v167, v179, v23
    v_accvgpr_read_b32 v176, a64
    v_accvgpr_read_b32 v177, a65
    v_accvgpr_read_b32 v178, a66
    v_accvgpr_read_b32 v179, a67
    v_accvgpr_write_b32 a64, 0
    v_accvgpr_write_b32 a65, 0
    v_accvgpr_write_b32 a66, 0
    v_accvgpr_write_b32 a67, 0
    v_mul_f32 v168, v176, v16
    v_mul_f32 v169, v177, v16
    v_mul_f32 v170, v178, v16
    v_mul_f32 v171, v179, v16
    v_accvgpr_read_b32 v176, a68
    v_accvgpr_read_b32 v177, a69
    v_accvgpr_read_b32 v178, a70
    v_accvgpr_read_b32 v179, a71
    v_accvgpr_write_b32 a68, 0
    v_accvgpr_write_b32 a69, 0
    v_accvgpr_write_b32 a70, 0
    v_accvgpr_write_b32 a71, 0
    v_fmac_f32 v168, v176, v17
    v_fmac_f32 v169, v177, v17
    v_fmac_f32 v170, v178, v17
    v_fmac_f32 v171, v179, v17
    v_accvgpr_read_b32 v176, a72
    v_accvgpr_read_b32 v177, a73
    v_accvgpr_read_b32 v178, a74
    v_accvgpr_read_b32 v179, a75
    v_accvgpr_write_b32 a72, 0
    v_accvgpr_write_b32 a73, 0
    v_accvgpr_write_b32 a74, 0
    v_accvgpr_write_b32 a75, 0
    v_fmac_f32 v168, v176, v18
    v_fmac_f32 v169, v177, v18
    v_fmac_f32 v170, v178, v18
    v_fmac_f32 v171, v179, v18
    v_accvgpr_read_b32 v176, a76
    v_accvgpr_read_b32 v177, a77
    v_accvgpr_read_b32 v178, a78
    v_accvgpr_read_b32 v179, a79
    v_accvgpr_write_b32 a76, 0
    v_accvgpr_write_b32 a77, 0
    v_accvgpr_write_b32 a78, 0
    v_accvgpr_write_b32 a79, 0
    v_fmac_f32 v168, v176, v19
    v_fmac_f32 v169, v177, v19
    v_fmac_f32 v170, v178, v19
    v_fmac_f32 v171, v179, v19
    v_accvgpr_read_b32 v176, a80
    v_accvgpr_read_b32 v177, a81
    v_accvgpr_read_b32 v178, a82
    v_accvgpr_read_b32 v179, a83
    v_accvgpr_write_b32 a80, 0
    v_accvgpr_write_b32 a81, 0
    v_accvgpr_write_b32 a82, 0
    v_accvgpr_write_b32 a83, 0
    v_fmac_f32 v168, v176, v20
    v_fmac_f32 v169, v177, v20
    v_fmac_f32 v170, v178, v20
    v_fmac_f32 v171, v179, v20
    v_accvgpr_read_b32 v176, a84
    v_accvgpr_read_b32 v177, a85
    v_accvgpr_read_b32 v178, a86
    v_accvgpr_read_b32 v179, a87
    v_accvgpr_write_b32 a84, 0
    v_accvgpr_write_b32 a85, 0
    v_accvgpr_write_b32 a86, 0
    v_accvgpr_write_b32 a87, 0
    v_fmac_f32 v168, v176, v21
    v_fmac_f32 v169, v177, v21
    v_fmac_f32 v170, v178, v21
    v_fmac_f32 v171, v179, v21
    v_accvgpr_read_b32 v176, a88
    v_accvgpr_read_b32 v177, a89
    v_accvgpr_read_b32 v178, a90
    v_accvgpr_read_b32 v179, a91
    v_accvgpr_write_b32 a88, 0
    v_accvgpr_write_b32 a89, 0
    v_accvgpr_write_b32 a90, 0
    v_accvgpr_write_b32 a91, 0
    v_fmac_f32 v168, v176, v22
    v_fmac_f32 v169, v177, v22
    v_fmac_f32 v170, v178, v22
    v_fmac_f32 v171, v179, v22
    v_accvgpr_read_b32 v176, a92
    v_accvgpr_read_b32 v177, a93
    v_accvgpr_read_b32 v178, a94
    v_accvgpr_read_b32 v179, a95
    v_accvgpr_write_b32 a92, 0
    v_accvgpr_write_b32 a93, 0
    v_accvgpr_write_b32 a94, 0
    v_accvgpr_write_b32 a95, 0
    v_fmac_f32 v168, v176, v23
    v_fmac_f32 v169, v177, v23
    v_fmac_f32 v170, v178, v23
    v_fmac_f32 v171, v179, v23
    v_accvgpr_read_b32 v176, a96
    v_accvgpr_read_b32 v177, a97
    v_accvgpr_read_b32 v178, a98
    v_accvgpr_read_b32 v179, a99
    v_accvgpr_write_b32 a96, 0
    v_accvgpr_write_b32 a97, 0
    v_accvgpr_write_b32 a98, 0
    v_accvgpr_write_b32 a99, 0
    v_mul_f32 v172, v176, v16
    v_mul_f32 v173, v177, v16
    v_mul_f32 v174, v178, v16
    v_mul_f32 v175, v179, v16
    v_accvgpr_read_b32 v176, a100
    v_accvgpr_read_b32 v177, a101
    v_accvgpr_read_b32 v178, a102
    v_accvgpr_read_b32 v179, a103
    v_accvgpr_write_b32 a100, 0
    v_accvgpr_write_b32 a101, 0
    v_accvgpr_write_b32 a102, 0
    v_accvgpr_write_b32 a103, 0
    v_fmac_f32 v172, v176, v17
    v_fmac_f32 v173, v177, v17
    v_fmac_f32 v174, v178, v17
    v_fmac_f32 v175, v179, v17
    v_accvgpr_read_b32 v176, a104
    v_accvgpr_read_b32 v177, a105
    v_accvgpr_read_b32 v178, a106
    v_accvgpr_read_b32 v179, a107
    v_accvgpr_write_b32 a104, 0
    v_accvgpr_write_b32 a105, 0
    v_accvgpr_write_b32 a106, 0
    v_accvgpr_write_b32 a107, 0
    v_fmac_f32 v172, v176, v18
    v_fmac_f32 v173, v177, v18
    v_fmac_f32 v174, v178, v18
    v_fmac_f32 v175, v179, v18
    v_accvgpr_read_b32 v176, a108
    v_accvgpr_read_b32 v177, a109
    v_accvgpr_read_b32 v178, a110
    v_accvgpr_read_b32 v179, a111
    v_accvgpr_write_b32 a108, 0
    v_accvgpr_write_b32 a109, 0
    v_accvgpr_write_b32 a110, 0
    v_accvgpr_write_b32 a111, 0
    v_fmac_f32 v172, v176, v19
    v_fmac_f32 v173, v177, v19
    v_fmac_f32 v174, v178, v19
    v_fmac_f32 v175, v179, v19
    v_accvgpr_read_b32 v176, a112
    v_accvgpr_read_b32 v177, a113
    v_accvgpr_read_b32 v178, a114
    v_accvgpr_read_b32 v179, a115
    v_accvgpr_write_b32 a112, 0
    v_accvgpr_write_b32 a113, 0
    v_accvgpr_write_b32 a114, 0
    v_accvgpr_write_b32 a115, 0
    v_fmac_f32 v172, v176, v20
    v_fmac_f32 v173, v177, v20
    v_fmac_f32 v174, v178, v20
    v_fmac_f32 v175, v179, v20
    v_accvgpr_read_b32 v176, a116
    v_accvgpr_read_b32 v177, a117
    v_accvgpr_read_b32 v178, a118
    v_accvgpr_read_b32 v179, a119
    v_accvgpr_write_b32 a116, 0
    v_accvgpr_write_b32 a117, 0
    v_accvgpr_write_b32 a118, 0
    v_accvgpr_write_b32 a119, 0
    v_fmac_f32 v172, v176, v21
    v_fmac_f32 v173, v177, v21
    v_fmac_f32 v174, v178, v21
    v_fmac_f32 v175, v179, v21
    v_accvgpr_read_b32 v176, a120
    v_accvgpr_read_b32 v177, a121
    v_accvgpr_read_b32 v178, a122
    v_accvgpr_read_b32 v179, a123
    v_accvgpr_write_b32 a120, 0
    v_accvgpr_write_b32 a121, 0
    v_accvgpr_write_b32 a122, 0
    v_accvgpr_write_b32 a123, 0
    v_fmac_f32 v172, v176, v22
    v_fmac_f32 v173, v177, v22
    v_fmac_f32 v174, v178, v22
    v_fmac_f32 v175, v179, v22
    v_accvgpr_read_b32 v176, a124
    v_accvgpr_read_b32 v177, a125
    v_accvgpr_read_b32 v178, a126
    v_accvgpr_read_b32 v179, a127
    v_accvgpr_write_b32 a124, 0
    v_accvgpr_write_b32 a125, 0
    v_accvgpr_write_b32 a126, 0
    v_accvgpr_write_b32 a127, 0
    v_fmac_f32 v172, v176, v23
    v_fmac_f32 v173, v177, v23
    v_fmac_f32 v174, v178, v23
    v_fmac_f32 v175, v179, v23
    v_add_f32_dpp v160, v160, v160 row_ror:8 row_mask:0xf bank_mask:0xf
    v_add_f32_dpp v161, v161, v161 row_ror:8 row_mask:0xf bank_mask:0xf
    v_add_f32_dpp v162, v162, v162 row_ror:8 row_mask:0xf bank_mask:0xf
    v_add_f32_dpp v163, v163, v163 row_ror:8 row_mask:0xf bank_mask:0xf
    v_add_f32_dpp v164, v164, v164 row_ror:8 row_mask:0xf bank_mask:0xf
    v_add_f32_dpp v165, v165, v165 row_ror:8 row_mask:0xf bank_mask:0xf
    v_add_f32_dpp v166, v166, v166 row_ror:8 row_mask:0xf bank_mask:0xf
    v_add_f32_dpp v167, v167, v167 row_ror:8 row_mask:0xf bank_mask:0xf
    v_add_f32_dpp v168, v168, v168 row_ror:8 row_mask:0xf bank_mask:0xf
    v_add_f32_dpp v169, v169, v169 row_ror:8 row_mask:0xf bank_mask:0xf
    v_add_f32_dpp v170, v170, v170 row_ror:8 row_mask:0xf bank_mask:0xf
    v_add_f32_dpp v171, v171, v171 row_ror:8 row_mask:0xf bank_mask:0xf
    v_add_f32_dpp v172, v172, v172 row_ror:8 row_mask:0xf bank_mask:0xf
    v_add_f32_dpp v173, v173, v173 row_ror:8 row_mask:0xf bank_mask:0xf
    v_add_f32_dpp v174, v174, v174 row_ror:8 row_mask:0xf bank_mask:0xf
    v_add_f32_dpp v175, v175, v175 row_ror:8 row_mask:0xf bank_mask:0xf
    v_add_f32_dpp v160, v160, v160 row_ror:4 row_mask:0xf bank_mask:0xf
    v_add_f32_dpp v161, v161, v161 row_ror:4 row_mask:0xf bank_mask:0xf
    v_add_f32_dpp v162, v162, v162 row_ror:4 row_mask:0xf bank_mask:0xf
    v_add_f32_dpp v163, v163, v163 row_ror:4 row_mask:0xf bank_mask:0xf
    v_add_f32_dpp v164, v164, v164 row_ror:4 row_mask:0xf bank_mask:0xf
    v_add_f32_dpp v165, v165, v165 row_ror:4 row_mask:0xf bank_mask:0xf
    v_add_f32_dpp v166, v166, v166 row_ror:4 row_mask:0xf bank_mask:0xf
    v_add_f32_dpp v167, v167, v167 row_ror:4 row_mask:0xf bank_mask:0xf
    v_add_f32_dpp v168, v168, v168 row_ror:4 row_mask:0xf bank_mask:0xf
    v_add_f32_dpp v169, v169, v169 row_ror:4 row_mask:0xf bank_mask:0xf
    v_add_f32_dpp v170, v170, v170 row_ror:4 row_mask:0xf bank_mask:0xf
    v_add_f32_dpp v171, v171, v171 row_ror:4 row_mask:0xf bank_mask:0xf
    v_add_f32_dpp v172, v172, v172 row_ror:4 row_mask:0xf bank_mask:0xf
    v_add_f32_dpp v173, v173, v173 row_ror:4 row_mask:0xf bank_mask:0xf
    v_add_f32_dpp v174, v174, v174 row_ror:4 row_mask:0xf bank_mask:0xf
    v_add_f32_dpp v175, v175, v175 row_ror:4 row_mask:0xf bank_mask:0xf
    v_add_f32_dpp v160, v160, v160 row_ror:2 row_mask:0xf bank_mask:0xf
    v_add_f32_dpp v161, v161, v161 row_ror:2 row_mask:0xf bank_mask:0xf
    v_add_f32_dpp v162, v162, v162 row_ror:2 row_mask:0xf bank_mask:0xf
    v_add_f32_dpp v163, v163, v163 row_ror:2 row_mask:0xf bank_mask:0xf
    v_add_f32_dpp v164, v164, v164 row_ror:2 row_mask:0xf bank_mask:0xf
    v_add_f32_dpp v165, v165, v165 row_ror:2 row_mask:0xf bank_mask:0xf
    v_add_f32_dpp v166, v166, v166 row_ror:2 row_mask:0xf bank_mask:0xf
    v_add_f32_dpp v167, v167, v167 row_ror:2 row_mask:0xf bank_mask:0xf
    v_add_f32_dpp v168, v168, v168 row_ror:2 row_mask:0xf bank_mask:0xf
    v_add_f32_dpp v169, v169, v169 row_ror:2 row_mask:0xf bank_mask:0xf
    v_add_f32_dpp v170, v170, v170 row_ror:2 row_mask:0xf bank_mask:0xf
    v_add_f32_dpp v171, v171, v171 row_ror:2 row_mask:0xf bank_mask:0xf
    v_add_f32_dpp v172, v172, v172 row_ror:2 row_mask:0xf bank_mask:0xf
    v_add_f32_dpp v173, v173, v173 row_ror:2 row_mask:0xf bank_mask:0xf
    v_add_f32_dpp v174, v174, v174 row_ror:2 row_mask:0xf bank_mask:0xf
    v_add_f32_dpp v175, v175, v175 row_ror:2 row_mask:0xf bank_mask:0xf
    v_add_f32_dpp v160, v160, v160 row_ror:1 row_mask:0xf bank_mask:0xf
    v_add_f32_dpp v161, v161, v161 row_ror:1 row_mask:0xf bank_mask:0xf
    v_add_f32_dpp v162, v162, v162 row_ror:1 row_mask:0xf bank_mask:0xf
    v_add_f32_dpp v163, v163, v163 row_ror:1 row_mask:0xf bank_mask:0xf
    v_add_f32_dpp v164, v164, v164 row_ror:1 row_mask:0xf bank_mask:0xf
    v_add_f32_dpp v165, v165, v165 row_ror:1 row_mask:0xf bank_mask:0xf
    v_add_f32_dpp v166, v166, v166 row_ror:1 row_mask:0xf bank_mask:0xf
    v_add_f32_dpp v167, v167, v167 row_ror:1 row_mask:0xf bank_mask:0xf
    v_add_f32_dpp v168, v168, v168 row_ror:1 row_mask:0xf bank_mask:0xf
    v_add_f32_dpp v169, v169, v169 row_ror:1 row_mask:0xf bank_mask:0xf
    v_add_f32_dpp v170, v170, v170 row_ror:1 row_mask:0xf bank_mask:0xf
    v_add_f32_dpp v171, v171, v171 row_ror:1 row_mask:0xf bank_mask:0xf
    v_add_f32_dpp v172, v172, v172 row_ror:1 row_mask:0xf bank_mask:0xf
    v_add_f32_dpp v173, v173, v173 row_ror:1 row_mask:0xf bank_mask:0xf
    v_add_f32_dpp v174, v174, v174 row_ror:1 row_mask:0xf bank_mask:0xf
    v_add_f32_dpp v175, v175, v175 row_ror:1 row_mask:0xf bank_mask:0xf
    s_lshl_b32 s59, s75, 8
    s_add_u32 s59, s59, s66
    s_mov_b32 exec_lo, 0x00010001
    s_mov_b32 exec_hi, 0x00010001
    buffer_store_dwordx4 v[160:163], v30, s[20:23], s59 offen offset:0 sc1
    buffer_store_dwordx4 v[164:167], v30, s[20:23], s59 offen offset:64 sc1
    buffer_store_dwordx4 v[168:171], v30, s[20:23], s59 offen offset:128 sc1
    buffer_store_dwordx4 v[172:175], v30, s[20:23], s59 offen offset:192 sc1
    s_mov_b64 exec, -1
    s_cmp_lg_u32 s75, 0
    s_cbranch_scc1 L_loop
    s_mov_b64 exec, 1
    buffer_store_dword v10, v10, s[20:23], s69 offen sc1
    s_mov_b64 exec, -1
    s_branch L_loop
L_publish:
    s_waitcnt vmcnt(48)
    s_mov_b64 exec, 1
    ds_add_rtn_u32 v12, v10, v11
    s_waitcnt lgkmcnt(0)
    v_readfirstlane_b32 s57, v12
    s_cmp_lg_u32 s57, 3
    s_cbranch_scc1 L_pub_done
    s_mov_b32 s58, s2
    buffer_store_byte v11, v10, s[24:27], s58 offen sc1
L_pub_done:
    s_mov_b64 exec, -1
    s_branch L_loop
L_poll:
    buffer_load_dwordx4 v[192:195], v10, s[24:27], s70 offen sc1
    s_branch L_loop
L_last:
    s_waitcnt vmcnt(48)
    s_mov_b32 s61, 0
L_check:
    v_mov_b32 v12, v192
    v_and_b32 v12, v12, v193
    v_and_b32 v12, v12, v194
    v_and_b32 v12, v12, v195
    v_cmp_eq_u32 vcc, 16843009, v12
    s_cbranch_vccnz L_ready
    s_add_u32 s61, s61, 1
    s_cmp_gt_u32 s61, 200000
    s_cbranch_scc1 L_ready
    buffer_load_dwordx4 v[192:195], v10, s[24:27], s70 offen sc1
    s_waitcnt vmcnt(0)
    s_branch L_check
L_ready:
    buffer_load_dwordx4 v[196:199], v31, s[20:23], s66 offen offset:0 sc1
    buffer_load_dwordx4 v[200:203], v31, s[20:23], s66 offen offset:1024 sc1
    buffer_load_dwordx4 v[204:207], v31, s[20:23], s66 offen offset:2048 sc1
    buffer_load_dwordx4 v[208:211], v31, s[20:23], s66 offen offset:3072 sc1
    s_waitcnt vmcnt(40)
    s_barrier
    v_perm_b32 v160, v36, v32, s35
    v_perm_b32 v161, v44, v40, s35
    v_perm_b32 v162, v52, v48, s35
    v_perm_b32 v163, v60, v56, s35
    v_perm_b32 v164, v36, v32, s52
    v_perm_b32 v165, v44, v40, s52
    v_perm_b32 v166, v52, v48, s52
    v_perm_b32 v167, v60, v56, s52
    v_perm_b32 v168, v37, v33, s35
    v_perm_b32 v169, v45, v41, s35
    v_perm_b32 v170, v53, v49, s35
    v_perm_b32 v171, v61, v57, s35
    v_perm_b32 v172, v37, v33, s52
    v_perm_b32 v173, v45, v41, s52
    v_perm_b32 v174, v53, v49, s52
    v_perm_b32 v175, v61, v57, s52
    v_perm_b32 v176, v38, v34, s35
    v_perm_b32 v177, v46, v42, s35
    v_perm_b32 v178, v54, v50, s35
    v_perm_b32 v179, v62, v58, s35
    v_perm_b32 v180, v38, v34, s52
    v_perm_b32 v181, v46, v42, s52
    v_perm_b32 v182, v54, v50, s52
    v_perm_b32 v183, v62, v58, s52
    v_perm_b32 v184, v39, v35, s35
    v_perm_b32 v185, v47, v43, s35
    v_perm_b32 v186, v55, v51, s35
    v_perm_b32 v187, v63, v59, s35
    v_perm_b32 v188, v39, v35, s52
    v_perm_b32 v189, v47, v43, s52
    v_perm_b32 v190, v55, v51, s52
    v_perm_b32 v191, v63, v59, s52
    s_nop 1
    v_mfma_f32_16x16x32_bf16 a[0:3], a[128:131], v[160:163], a[0:3]
    v_mfma_f32_16x16x32_bf16 a[32:35], a[132:135], v[160:163], a[32:35]
    v_mfma_f32_16x16x32_bf16 a[64:67], a[136:139], v[160:163], a[64:67]
    v_mfma_f32_16x16x32_bf16 a[96:99], a[140:143], v[160:163], a[96:99]
    v_mfma_f32_16x16x32_bf16 a[4:7], a[128:131], v[164:167], a[4:7]
    v_mfma_f32_16x16x32_bf16 a[36:39], a[132:135], v[164:167], a[36:39]
    v_mfma_f32_16x16x32_bf16 a[68:71], a[136:139], v[164:167], a[68:71]
    v_mfma_f32_16x16x32_bf16 a[100:103], a[140:143], v[164:167], a[100:103]
    v_mfma_f32_16x16x32_bf16 a[8:11], a[128:131], v[168:171], a[8:11]
    v_mfma_f32_16x16x32_bf16 a[40:43], a[132:135], v[168:171], a[40:43]
    v_mfma_f32_16x16x32_bf16 a[72:75], a[136:139], v[168:171], a[72:75]
    v_mfma_f32_16x16x32_bf16 a[104:107], a[140:143], v[168:171], a[104:107]
    v_mfma_f32_16x16x32_bf16 a[12:15], a[128:131], v[172:175], a[12:15]
    v_mfma_f32_16x16x32_bf16 a[44:47], a[132:135], v[172:175], a[44:47]
    v_mfma_f32_16x16x32_bf16 a[76:79], a[136:139], v[172:175], a[76:79]
    v_mfma_f32_16x16x32_bf16 a[108:111], a[140:143], v[172:175], a[108:111]
    v_mfma_f32_16x16x32_bf16 a[16:19], a[128:131], v[176:179], a[16:19]
    v_mfma_f32_16x16x32_bf16 a[48:51], a[132:135], v[176:179], a[48:51]
    v_mfma_f32_16x16x32_bf16 a[80:83], a[136:139], v[176:179], a[80:83]
    v_mfma_f32_16x16x32_bf16 a[112:115], a[140:143], v[176:179], a[112:115]
    v_mfma_f32_16x16x32_bf16 a[20:23], a[128:131], v[180:183], a[20:23]
    v_mfma_f32_16x16x32_bf16 a[52:55], a[132:135], v[180:183], a[52:55]
    v_mfma_f32_16x16x32_bf16 a[84:87], a[136:139], v[180:183], a[84:87]
    v_mfma_f32_16x16x32_bf16 a[116:119], a[140:143], v[180:183], a[116:119]
    v_mfma_f32_16x16x32_bf16 a[24:27], a[128:131], v[184:187], a[24:27]
    v_mfma_f32_16x16x32_bf16 a[56:59], a[132:135], v[184:187], a[56:59]
    v_mfma_f32_16x16x32_bf16 a[88:91], a[136:139], v[184:187], a[88:91]
    v_mfma_f32_16x16x32_bf16 a[120:123], a[140:143], v[184:187], a[120:123]
    v_mfma_f32_16x16x32_bf16 a[28:31], a[128:131], v[188:191], a[28:31]
    v_mfma_f32_16x16x32_bf16 a[60:63], a[132:135], v[188:191], a[60:63]
    v_mfma_f32_16x16x32_bf16 a[92:95], a[136:139], v[188:191], a[92:95]
    v_mfma_f32_16x16x32_bf16 a[124:127], a[140:143], v[188:191], a[124:127]
    s_waitcnt vmcnt(28)
    v_perm_b32 v160, v68, v64, s35
    v_perm_b32 v161, v76, v72, s35
    v_perm_b32 v162, v84, v80, s35
    v_perm_b32 v163, v92, v88, s35
    v_perm_b32 v164, v68, v64, s52
    v_perm_b32 v165, v76, v72, s52
    v_perm_b32 v166, v84, v80, s52
    v_perm_b32 v167, v92, v88, s52
    v_perm_b32 v168, v69, v65, s35
    v_perm_b32 v169, v77, v73, s35
    v_perm_b32 v170, v85, v81, s35
    v_perm_b32 v171, v93, v89, s35
    v_perm_b32 v172, v69, v65, s52
    v_perm_b32 v173, v77, v73, s52
    v_perm_b32 v174, v85, v81, s52
    v_perm_b32 v175, v93, v89, s52
    v_perm_b32 v176, v70, v66, s35
    v_perm_b32 v177, v78, v74, s35
    v_perm_b32 v178, v86, v82, s35
    v_perm_b32 v179, v94, v90, s35
    v_perm_b32 v180, v70, v66, s52
    v_perm_b32 v181, v78, v74, s52
    v_perm_b32 v182, v86, v82, s52
    v_perm_b32 v183, v94, v90, s52
    v_perm_b32 v184, v71, v67, s35
    v_perm_b32 v185, v79, v75, s35
    v_perm_b32 v186, v87, v83, s35
    v_perm_b32 v187, v95, v91, s35
    v_perm_b32 v188, v71, v67, s52
    v_perm_b32 v189, v79, v75, s52
    v_perm_b32 v190, v87, v83, s52
    v_perm_b32 v191, v95, v91, s52
    s_nop 1
    v_mfma_f32_16x16x32_bf16 a[0:3], a[144:147], v[160:163], a[0:3]
    v_mfma_f32_16x16x32_bf16 a[32:35], a[148:151], v[160:163], a[32:35]
    v_mfma_f32_16x16x32_bf16 a[64:67], a[152:155], v[160:163], a[64:67]
    v_mfma_f32_16x16x32_bf16 a[96:99], a[156:159], v[160:163], a[96:99]
    v_mfma_f32_16x16x32_bf16 a[4:7], a[144:147], v[164:167], a[4:7]
    v_mfma_f32_16x16x32_bf16 a[36:39], a[148:151], v[164:167], a[36:39]
    v_mfma_f32_16x16x32_bf16 a[68:71], a[152:155], v[164:167], a[68:71]
    v_mfma_f32_16x16x32_bf16 a[100:103], a[156:159], v[164:167], a[100:103]
    v_mfma_f32_16x16x32_bf16 a[8:11], a[144:147], v[168:171], a[8:11]
    v_mfma_f32_16x16x32_bf16 a[40:43], a[148:151], v[168:171], a[40:43]
    v_mfma_f32_16x16x32_bf16 a[72:75], a[152:155], v[168:171], a[72:75]
    v_mfma_f32_16x16x32_bf16 a[104:107], a[156:159], v[168:171], a[104:107]
    v_mfma_f32_16x16x32_bf16 a[12:15], a[144:147], v[172:175], a[12:15]
    v_mfma_f32_16x16x32_bf16 a[44:47], a[148:151], v[172:175], a[44:47]
    v_mfma_f32_16x16x32_bf16 a[76:79], a[152:155], v[172:175], a[76:79]
    v_mfma_f32_16x16x32_bf16 a[108:111], a[156:159], v[172:175], a[108:111]
    v_mfma_f32_16x16x32_bf16 a[16:19], a[144:147], v[176:179], a[16:19]
    v_mfma_f32_16x16x32_bf16 a[48:51], a[148:151], v[176:179], a[48:51]
    v_mfma_f32_16x16x32_bf16 a[80:83], a[152:155], v[176:179], a[80:83]
    v_mfma_f32_16x16x32_bf16 a[112:115], a[156:159], v[176:179], a[112:115]
    v_mfma_f32_16x16x32_bf16 a[20:23], a[144:147], v[180:183], a[20:23]
    v_mfma_f32_16x16x32_bf16 a[52:55], a[148:151], v[180:183], a[52:55]
    v_mfma_f32_16x16x32_bf16 a[84:87], a[152:155], v[180:183], a[84:87]
    v_mfma_f32_16x16x32_bf16 a[116:119], a[156:159], v[180:183], a[116:119]
    v_mfma_f32_16x16x32_bf16 a[24:27], a[144:147], v[184:187], a[24:27]
    v_mfma_f32_16x16x32_bf16 a[56:59], a[148:151], v[184:187], a[56:59]
    v_mfma_f32_16x16x32_bf16 a[88:91], a[152:155], v[184:187], a[88:91]
    v_mfma_f32_16x16x32_bf16 a[120:123], a[156:159], v[184:187], a[120:123]
    v_mfma_f32_16x16x32_bf16 a[28:31], a[144:147], v[188:191], a[28:31]
    v_mfma_f32_16x16x32_bf16 a[60:63], a[148:151], v[188:191], a[60:63]
    v_mfma_f32_16x16x32_bf16 a[92:95], a[152:155], v[188:191], a[92:95]
    v_mfma_f32_16x16x32_bf16 a[124:127], a[156:159], v[188:191], a[124:127]
    s_waitcnt vmcnt(16)
    v_perm_b32 v160, v100, v96, s35
    v_perm_b32 v161, v108, v104, s35
    v_perm_b32 v162, v116, v112, s35
    v_perm_b32 v163, v124, v120, s35
    v_perm_b32 v164, v100, v96, s52
    v_perm_b32 v165, v108, v104, s52
    v_perm_b32 v166, v116, v112, s52
    v_perm_b32 v167, v124, v120, s52
    v_perm_b32 v168, v101, v97, s35
    v_perm_b32 v169, v109, v105, s35
    v_perm_b32 v170, v117, v113, s35
    v_perm_b32 v171, v125, v121, s35
    v_perm_b32 v172, v101, v97, s52
    v_perm_b32 v173, v109, v105, s52
    v_perm_b32 v174, v117, v113, s52
    v_perm_b32 v175, v125, v121, s52
    v_perm_b32 v176, v102, v98, s35
    v_perm_b32 v177, v110, v106, s35
    v_perm_b32 v178, v118, v114, s35
    v_perm_b32 v179, v126, v122, s35
    v_perm_b32 v180, v102, v98, s52
    v_perm_b32 v181, v110, v106, s52
    v_perm_b32 v182, v118, v114, s52
    v_perm_b32 v183, v126, v122, s52
    v_perm_b32 v184, v103, v99, s35
    v_perm_b32 v185, v111, v107, s35
    v_perm_b32 v186, v119, v115, s35
    v_perm_b32 v187, v127, v123, s35
    v_perm_b32 v188, v103, v99, s52
    v_perm_b32 v189, v111, v107, s52
    v_perm_b32 v190, v119, v115, s52
    v_perm_b32 v191, v127, v123, s52
    s_nop 1
    v_mfma_f32_16x16x32_bf16 a[0:3], a[160:163], v[160:163], a[0:3]
    v_mfma_f32_16x16x32_bf16 a[32:35], a[164:167], v[160:163], a[32:35]
    v_mfma_f32_16x16x32_bf16 a[64:67], a[168:171], v[160:163], a[64:67]
    v_mfma_f32_16x16x32_bf16 a[96:99], a[172:175], v[160:163], a[96:99]
    v_mfma_f32_16x16x32_bf16 a[4:7], a[160:163], v[164:167], a[4:7]
    v_mfma_f32_16x16x32_bf16 a[36:39], a[164:167], v[164:167], a[36:39]
    v_mfma_f32_16x16x32_bf16 a[68:71], a[168:171], v[164:167], a[68:71]
    v_mfma_f32_16x16x32_bf16 a[100:103], a[172:175], v[164:167], a[100:103]
    v_mfma_f32_16x16x32_bf16 a[8:11], a[160:163], v[168:171], a[8:11]
    v_mfma_f32_16x16x32_bf16 a[40:43], a[164:167], v[168:171], a[40:43]
    v_mfma_f32_16x16x32_bf16 a[72:75], a[168:171], v[168:171], a[72:75]
    v_mfma_f32_16x16x32_bf16 a[104:107], a[172:175], v[168:171], a[104:107]
    v_mfma_f32_16x16x32_bf16 a[12:15], a[160:163], v[172:175], a[12:15]
    v_mfma_f32_16x16x32_bf16 a[44:47], a[164:167], v[172:175], a[44:47]
    v_mfma_f32_16x16x32_bf16 a[76:79], a[168:171], v[172:175], a[76:79]
    v_mfma_f32_16x16x32_bf16 a[108:111], a[172:175], v[172:175], a[108:111]
    v_mfma_f32_16x16x32_bf16 a[16:19], a[160:163], v[176:179], a[16:19]
    v_mfma_f32_16x16x32_bf16 a[48:51], a[164:167], v[176:179], a[48:51]
    v_mfma_f32_16x16x32_bf16 a[80:83], a[168:171], v[176:179], a[80:83]
    v_mfma_f32_16x16x32_bf16 a[112:115], a[172:175], v[176:179], a[112:115]
    v_mfma_f32_16x16x32_bf16 a[20:23], a[160:163], v[180:183], a[20:23]
    v_mfma_f32_16x16x32_bf16 a[52:55], a[164:167], v[180:183], a[52:55]
    v_mfma_f32_16x16x32_bf16 a[84:87], a[168:171], v[180:183], a[84:87]
    v_mfma_f32_16x16x32_bf16 a[116:119], a[172:175], v[180:183], a[116:119]
    v_mfma_f32_16x16x32_bf16 a[24:27], a[160:163], v[184:187], a[24:27]
    v_mfma_f32_16x16x32_bf16 a[56:59], a[164:167], v[184:187], a[56:59]
    v_mfma_f32_16x16x32_bf16 a[88:91], a[168:171], v[184:187], a[88:91]
    v_mfma_f32_16x16x32_bf16 a[120:123], a[172:175], v[184:187], a[120:123]
    v_mfma_f32_16x16x32_bf16 a[28:31], a[160:163], v[188:191], a[28:31]
    v_mfma_f32_16x16x32_bf16 a[60:63], a[164:167], v[188:191], a[60:63]
    v_mfma_f32_16x16x32_bf16 a[92:95], a[168:171], v[188:191], a[92:95]
    v_mfma_f32_16x16x32_bf16 a[124:127], a[172:175], v[188:191], a[124:127]
    s_waitcnt vmcnt(4)
    v_perm_b32 v160, v132, v128, s35
    v_perm_b32 v161, v140, v136, s35
    v_perm_b32 v162, v148, v144, s35
    v_perm_b32 v163, v156, v152, s35
    v_perm_b32 v164, v132, v128, s52
    v_perm_b32 v165, v140, v136, s52
    v_perm_b32 v166, v148, v144, s52
    v_perm_b32 v167, v156, v152, s52
    v_perm_b32 v168, v133, v129, s35
    v_perm_b32 v169, v141, v137, s35
    v_perm_b32 v170, v149, v145, s35
    v_perm_b32 v171, v157, v153, s35
    v_perm_b32 v172, v133, v129, s52
    v_perm_b32 v173, v141, v137, s52
    v_perm_b32 v174, v149, v145, s52
    v_perm_b32 v175, v157, v153, s52
    v_perm_b32 v176, v134, v130, s35
    v_perm_b32 v177, v142, v138, s35
    v_perm_b32 v178, v150, v146, s35
    v_perm_b32 v179, v158, v154, s35
    v_perm_b32 v180, v134, v130, s52
    v_perm_b32 v181, v142, v138, s52
    v_perm_b32 v182, v150, v146, s52
    v_perm_b32 v183, v158, v154, s52
    v_perm_b32 v184, v135, v131, s35
    v_perm_b32 v185, v143, v139, s35
    v_perm_b32 v186, v151, v147, s35
    v_perm_b32 v187, v159, v155, s35
    v_perm_b32 v188, v135, v131, s52
    v_perm_b32 v189, v143, v139, s52
    v_perm_b32 v190, v151, v147, s52
    v_perm_b32 v191, v159, v155, s52
    s_nop 1
    v_mfma_f32_16x16x32_bf16 a[0:3], a[176:179], v[160:163], a[0:3]
    v_mfma_f32_16x16x32_bf16 a[32:35], a[180:183], v[160:163], a[32:35]
    v_mfma_f32_16x16x32_bf16 a[64:67], a[184:187], v[160:163], a[64:67]
    v_mfma_f32_16x16x32_bf16 a[96:99], a[188:191], v[160:163], a[96:99]
    v_mfma_f32_16x16x32_bf16 a[4:7], a[176:179], v[164:167], a[4:7]
    v_mfma_f32_16x16x32_bf16 a[36:39], a[180:183], v[164:167], a[36:39]
    v_mfma_f32_16x16x32_bf16 a[68:71], a[184:187], v[164:167], a[68:71]
    v_mfma_f32_16x16x32_bf16 a[100:103], a[188:191], v[164:167], a[100:103]
    v_mfma_f32_16x16x32_bf16 a[8:11], a[176:179], v[168:171], a[8:11]
    v_mfma_f32_16x16x32_bf16 a[40:43], a[180:183], v[168:171], a[40:43]
    v_mfma_f32_16x16x32_bf16 a[72:75], a[184:187], v[168:171], a[72:75]
    v_mfma_f32_16x16x32_bf16 a[104:107], a[188:191], v[168:171], a[104:107]
    v_mfma_f32_16x16x32_bf16 a[12:15], a[176:179], v[172:175], a[12:15]
    v_mfma_f32_16x16x32_bf16 a[44:47], a[180:183], v[172:175], a[44:47]
    v_mfma_f32_16x16x32_bf16 a[76:79], a[184:187], v[172:175], a[76:79]
    v_mfma_f32_16x16x32_bf16 a[108:111], a[188:191], v[172:175], a[108:111]
    v_mfma_f32_16x16x32_bf16 a[16:19], a[176:179], v[176:179], a[16:19]
    v_mfma_f32_16x16x32_bf16 a[48:51], a[180:183], v[176:179], a[48:51]
    v_mfma_f32_16x16x32_bf16 a[80:83], a[184:187], v[176:179], a[80:83]
    v_mfma_f32_16x16x32_bf16 a[112:115], a[188:191], v[176:179], a[112:115]
    v_mfma_f32_16x16x32_bf16 a[20:23], a[176:179], v[180:183], a[20:23]
    v_mfma_f32_16x16x32_bf16 a[52:55], a[180:183], v[180:183], a[52:55]
    v_mfma_f32_16x16x32_bf16 a[84:87], a[184:187], v[180:183], a[84:87]
    v_mfma_f32_16x16x32_bf16 a[116:119], a[188:191], v[180:183], a[116:119]
    v_mfma_f32_16x16x32_bf16 a[24:27], a[176:179], v[184:187], a[24:27]
    v_mfma_f32_16x16x32_bf16 a[56:59], a[180:183], v[184:187], a[56:59]
    v_mfma_f32_16x16x32_bf16 a[88:91], a[184:187], v[184:187], a[88:91]
    v_mfma_f32_16x16x32_bf16 a[120:123], a[188:191], v[184:187], a[120:123]
    v_mfma_f32_16x16x32_bf16 a[28:31], a[176:179], v[188:191], a[28:31]
    v_mfma_f32_16x16x32_bf16 a[60:63], a[180:183], v[188:191], a[60:63]
    v_mfma_f32_16x16x32_bf16 a[92:95], a[184:187], v[188:191], a[92:95]
    v_mfma_f32_16x16x32_bf16 a[124:127], a[188:191], v[188:191], a[124:127]
    s_waitcnt vmcnt(0)
    v_add_f32 v160, v196, v200
    v_add_f32 v164, v204, v208
    v_add_f32 v161, v197, v201
    v_add_f32 v165, v205, v209
    v_add_f32 v162, v198, v202
    v_add_f32 v166, v206, v210
    v_add_f32 v163, v199, v203
    v_add_f32 v167, v207, v211
    v_add_f32 v160, v160, v164
    v_add_f32 v161, v161, v165
    v_add_f32 v162, v162, v166
    v_add_f32 v163, v163, v167
    v_mov_b32 v164, v160
    v_mov_b32 v165, v161
    v_mov_b32 v166, v162
    v_mov_b32 v167, v163
    s_nop 1
    v_permlane16_swap_b32 v160, v164
    v_permlane16_swap_b32 v161, v165
    v_permlane16_swap_b32 v162, v166
    v_permlane16_swap_b32 v163, v167
    v_add_f32 v160, v160, v164
    v_add_f32 v161, v161, v165
    v_add_f32 v162, v162, v166
    v_add_f32 v163, v163, v167
    v_mov_b32 v164, v160
    v_mov_b32 v165, v161
    v_mov_b32 v166, v162
    v_mov_b32 v167, v163
    s_nop 1
    v_permlane32_swap_b32 v160, v164
    v_permlane32_swap_b32 v161, v165
    v_permlane32_swap_b32 v162, v166
    v_permlane32_swap_b32 v163, v167
    v_add_f32 v160, v160, v164
    v_add_f32 v161, v161, v165
    v_add_f32 v162, v162, v166
    v_add_f32 v163, v163, v167
    v_mul_f32 v160, s71, v160
    v_mul_f32 v161, s71, v161
    v_mul_f32 v162, s71, v162
    v_mul_f32 v163, s71, v163
    v_max_f32 v164, v160, v161
    v_max_f32 v165, v162, v163
    v_max_f32 v164, v164, v165
    s_nop 1
    v_max_f32_dpp v164, v164, v164 row_ror:8 row_mask:0xf bank_mask:0xf
    s_nop 1
    v_max_f32_dpp v164, v164, v164 row_ror:4 row_mask:0xf bank_mask:0xf
    s_nop 1
    v_max_f32_dpp v164, v164, v164 row_ror:2 row_mask:0xf bank_mask:0xf
    s_nop 1
    v_max_f32_dpp v164, v164, v164 row_ror:1 row_mask:0xf bank_mask:0xf
    v_sub_f32 v160, v160, v164
    v_sub_f32 v161, v161, v164
    v_sub_f32 v162, v162, v164
    v_sub_f32 v163, v163, v164
    v_exp_f32 v160, v160
    v_exp_f32 v161, v161
    v_exp_f32 v162, v162
    v_exp_f32 v163, v163
    s_nop 0
    v_add_f32 v165, v160, v161
    v_add_f32 v166, v162, v163
    v_add_f32 v165, v165, v166
    s_nop 1
    v_add_f32_dpp v165, v165, v165 row_ror:8 row_mask:0xf bank_mask:0xf
    s_nop 1
    v_add_f32_dpp v165, v165, v165 row_ror:4 row_mask:0xf bank_mask:0xf
    s_nop 1
    v_add_f32_dpp v165, v165, v165 row_ror:2 row_mask:0xf bank_mask:0xf
    s_nop 1
    v_add_f32_dpp v165, v165, v165 row_ror:1 row_mask:0xf bank_mask:0xf
    v_rcp_f32 v166, v165
    s_nop 0
    v_fma_f32 v167, -v165, v166, 2.0
    v_mul_f32 v166, v166, v167
    v_mul_f32 v160, v160, v166
    v_mul_f32 v161, v161, v166
    v_mul_f32 v162, v162, v166
    v_mul_f32 v163, v163, v166
    ds_write_b128 v28, v[160:163]
    s_waitcnt lgkmcnt(0)
    ds_read_b128 v[212:215], v29 offset:0
    ds_read_b128 v[216:219], v29 offset:64
    ds_read_b128 v[220:223], v29 offset:128
    ds_read_b128 v[224:227], v29 offset:192
    s_waitcnt lgkmcnt(0)
    v_accvgpr_read_b32 v168, a0
    v_accvgpr_read_b32 v169, a1
    v_accvgpr_read_b32 v170, a2
    v_accvgpr_read_b32 v171, a3
    v_mul_f32 v160, v168, v212
    v_fmac_f32 v160, v169, v213
    v_fmac_f32 v160, v170, v214
    v_fmac_f32 v160, v171, v215
    v_accvgpr_read_b32 v168, a4
    v_accvgpr_read_b32 v169, a5
    v_accvgpr_read_b32 v170, a6
    v_accvgpr_read_b32 v171, a7
    v_mul_f32 v161, v168, v212
    v_fmac_f32 v161, v169, v213
    v_fmac_f32 v161, v170, v214
    v_fmac_f32 v161, v171, v215
    v_accvgpr_read_b32 v168, a8
    v_accvgpr_read_b32 v169, a9
    v_accvgpr_read_b32 v170, a10
    v_accvgpr_read_b32 v171, a11
    v_mul_f32 v162, v168, v212
    v_fmac_f32 v162, v169, v213
    v_fmac_f32 v162, v170, v214
    v_fmac_f32 v162, v171, v215
    v_accvgpr_read_b32 v168, a12
    v_accvgpr_read_b32 v169, a13
    v_accvgpr_read_b32 v170, a14
    v_accvgpr_read_b32 v171, a15
    v_mul_f32 v163, v168, v212
    v_fmac_f32 v163, v169, v213
    v_fmac_f32 v163, v170, v214
    v_fmac_f32 v163, v171, v215
    v_accvgpr_read_b32 v168, a16
    v_accvgpr_read_b32 v169, a17
    v_accvgpr_read_b32 v170, a18
    v_accvgpr_read_b32 v171, a19
    v_mul_f32 v164, v168, v212
    v_fmac_f32 v164, v169, v213
    v_fmac_f32 v164, v170, v214
    v_fmac_f32 v164, v171, v215
    v_accvgpr_read_b32 v168, a20
    v_accvgpr_read_b32 v169, a21
    v_accvgpr_read_b32 v170, a22
    v_accvgpr_read_b32 v171, a23
    v_mul_f32 v165, v168, v212
    v_fmac_f32 v165, v169, v213
    v_fmac_f32 v165, v170, v214
    v_fmac_f32 v165, v171, v215
    v_accvgpr_read_b32 v168, a24
    v_accvgpr_read_b32 v169, a25
    v_accvgpr_read_b32 v170, a26
    v_accvgpr_read_b32 v171, a27
    v_mul_f32 v166, v168, v212
    v_fmac_f32 v166, v169, v213
    v_fmac_f32 v166, v170, v214
    v_fmac_f32 v166, v171, v215
    v_accvgpr_read_b32 v168, a28
    v_accvgpr_read_b32 v169, a29
    v_accvgpr_read_b32 v170, a30
    v_accvgpr_read_b32 v171, a31
    v_mul_f32 v167, v168, v212
    v_fmac_f32 v167, v169, v213
    v_fmac_f32 v167, v170, v214
    v_fmac_f32 v167, v171, v215
    v_accvgpr_read_b32 v168, a32
    v_accvgpr_read_b32 v169, a33
    v_accvgpr_read_b32 v170, a34
    v_accvgpr_read_b32 v171, a35
    v_fmac_f32 v160, v168, v216
    v_fmac_f32 v160, v169, v217
    v_fmac_f32 v160, v170, v218
    v_fmac_f32 v160, v171, v219
    v_accvgpr_read_b32 v168, a36
    v_accvgpr_read_b32 v169, a37
    v_accvgpr_read_b32 v170, a38
    v_accvgpr_read_b32 v171, a39
    v_fmac_f32 v161, v168, v216
    v_fmac_f32 v161, v169, v217
    v_fmac_f32 v161, v170, v218
    v_fmac_f32 v161, v171, v219
    v_accvgpr_read_b32 v168, a40
    v_accvgpr_read_b32 v169, a41
    v_accvgpr_read_b32 v170, a42
    v_accvgpr_read_b32 v171, a43
    v_fmac_f32 v162, v168, v216
    v_fmac_f32 v162, v169, v217
    v_fmac_f32 v162, v170, v218
    v_fmac_f32 v162, v171, v219
    v_accvgpr_read_b32 v168, a44
    v_accvgpr_read_b32 v169, a45
    v_accvgpr_read_b32 v170, a46
    v_accvgpr_read_b32 v171, a47
    v_fmac_f32 v163, v168, v216
    v_fmac_f32 v163, v169, v217
    v_fmac_f32 v163, v170, v218
    v_fmac_f32 v163, v171, v219
    v_accvgpr_read_b32 v168, a48
    v_accvgpr_read_b32 v169, a49
    v_accvgpr_read_b32 v170, a50
    v_accvgpr_read_b32 v171, a51
    v_fmac_f32 v164, v168, v216
    v_fmac_f32 v164, v169, v217
    v_fmac_f32 v164, v170, v218
    v_fmac_f32 v164, v171, v219
    v_accvgpr_read_b32 v168, a52
    v_accvgpr_read_b32 v169, a53
    v_accvgpr_read_b32 v170, a54
    v_accvgpr_read_b32 v171, a55
    v_fmac_f32 v165, v168, v216
    v_fmac_f32 v165, v169, v217
    v_fmac_f32 v165, v170, v218
    v_fmac_f32 v165, v171, v219
    v_accvgpr_read_b32 v168, a56
    v_accvgpr_read_b32 v169, a57
    v_accvgpr_read_b32 v170, a58
    v_accvgpr_read_b32 v171, a59
    v_fmac_f32 v166, v168, v216
    v_fmac_f32 v166, v169, v217
    v_fmac_f32 v166, v170, v218
    v_fmac_f32 v166, v171, v219
    v_accvgpr_read_b32 v168, a60
    v_accvgpr_read_b32 v169, a61
    v_accvgpr_read_b32 v170, a62
    v_accvgpr_read_b32 v171, a63
    v_fmac_f32 v167, v168, v216
    v_fmac_f32 v167, v169, v217
    v_fmac_f32 v167, v170, v218
    v_fmac_f32 v167, v171, v219
    v_accvgpr_read_b32 v168, a64
    v_accvgpr_read_b32 v169, a65
    v_accvgpr_read_b32 v170, a66
    v_accvgpr_read_b32 v171, a67
    v_fmac_f32 v160, v168, v220
    v_fmac_f32 v160, v169, v221
    v_fmac_f32 v160, v170, v222
    v_fmac_f32 v160, v171, v223
    v_accvgpr_read_b32 v168, a68
    v_accvgpr_read_b32 v169, a69
    v_accvgpr_read_b32 v170, a70
    v_accvgpr_read_b32 v171, a71
    v_fmac_f32 v161, v168, v220
    v_fmac_f32 v161, v169, v221
    v_fmac_f32 v161, v170, v222
    v_fmac_f32 v161, v171, v223
    v_accvgpr_read_b32 v168, a72
    v_accvgpr_read_b32 v169, a73
    v_accvgpr_read_b32 v170, a74
    v_accvgpr_read_b32 v171, a75
    v_fmac_f32 v162, v168, v220
    v_fmac_f32 v162, v169, v221
    v_fmac_f32 v162, v170, v222
    v_fmac_f32 v162, v171, v223
    v_accvgpr_read_b32 v168, a76
    v_accvgpr_read_b32 v169, a77
    v_accvgpr_read_b32 v170, a78
    v_accvgpr_read_b32 v171, a79
    v_fmac_f32 v163, v168, v220
    v_fmac_f32 v163, v169, v221
    v_fmac_f32 v163, v170, v222
    v_fmac_f32 v163, v171, v223
    v_accvgpr_read_b32 v168, a80
    v_accvgpr_read_b32 v169, a81
    v_accvgpr_read_b32 v170, a82
    v_accvgpr_read_b32 v171, a83
    v_fmac_f32 v164, v168, v220
    v_fmac_f32 v164, v169, v221
    v_fmac_f32 v164, v170, v222
    v_fmac_f32 v164, v171, v223
    v_accvgpr_read_b32 v168, a84
    v_accvgpr_read_b32 v169, a85
    v_accvgpr_read_b32 v170, a86
    v_accvgpr_read_b32 v171, a87
    v_fmac_f32 v165, v168, v220
    v_fmac_f32 v165, v169, v221
    v_fmac_f32 v165, v170, v222
    v_fmac_f32 v165, v171, v223
    v_accvgpr_read_b32 v168, a88
    v_accvgpr_read_b32 v169, a89
    v_accvgpr_read_b32 v170, a90
    v_accvgpr_read_b32 v171, a91
    v_fmac_f32 v166, v168, v220
    v_fmac_f32 v166, v169, v221
    v_fmac_f32 v166, v170, v222
    v_fmac_f32 v166, v171, v223
    v_accvgpr_read_b32 v168, a92
    v_accvgpr_read_b32 v169, a93
    v_accvgpr_read_b32 v170, a94
    v_accvgpr_read_b32 v171, a95
    v_fmac_f32 v167, v168, v220
    v_fmac_f32 v167, v169, v221
    v_fmac_f32 v167, v170, v222
    v_fmac_f32 v167, v171, v223
    v_accvgpr_read_b32 v168, a96
    v_accvgpr_read_b32 v169, a97
    v_accvgpr_read_b32 v170, a98
    v_accvgpr_read_b32 v171, a99
    v_fmac_f32 v160, v168, v224
    v_fmac_f32 v160, v169, v225
    v_fmac_f32 v160, v170, v226
    v_fmac_f32 v160, v171, v227
    v_accvgpr_read_b32 v168, a100
    v_accvgpr_read_b32 v169, a101
    v_accvgpr_read_b32 v170, a102
    v_accvgpr_read_b32 v171, a103
    v_fmac_f32 v161, v168, v224
    v_fmac_f32 v161, v169, v225
    v_fmac_f32 v161, v170, v226
    v_fmac_f32 v161, v171, v227
    v_accvgpr_read_b32 v168, a104
    v_accvgpr_read_b32 v169, a105
    v_accvgpr_read_b32 v170, a106
    v_accvgpr_read_b32 v171, a107
    v_fmac_f32 v162, v168, v224
    v_fmac_f32 v162, v169, v225
    v_fmac_f32 v162, v170, v226
    v_fmac_f32 v162, v171, v227
    v_accvgpr_read_b32 v168, a108
    v_accvgpr_read_b32 v169, a109
    v_accvgpr_read_b32 v170, a110
    v_accvgpr_read_b32 v171, a111
    v_fmac_f32 v163, v168, v224
    v_fmac_f32 v163, v169, v225
    v_fmac_f32 v163, v170, v226
    v_fmac_f32 v163, v171, v227
    v_accvgpr_read_b32 v168, a112
    v_accvgpr_read_b32 v169, a113
    v_accvgpr_read_b32 v170, a114
    v_accvgpr_read_b32 v171, a115
    v_fmac_f32 v164, v168, v224
    v_fmac_f32 v164, v169, v225
    v_fmac_f32 v164, v170, v226
    v_fmac_f32 v164, v171, v227
    v_accvgpr_read_b32 v168, a116
    v_accvgpr_read_b32 v169, a117
    v_accvgpr_read_b32 v170, a118
    v_accvgpr_read_b32 v171, a119
    v_fmac_f32 v165, v168, v224
    v_fmac_f32 v165, v169, v225
    v_fmac_f32 v165, v170, v226
    v_fmac_f32 v165, v171, v227
    v_accvgpr_read_b32 v168, a120
    v_accvgpr_read_b32 v169, a121
    v_accvgpr_read_b32 v170, a122
    v_accvgpr_read_b32 v171, a123
    v_fmac_f32 v166, v168, v224
    v_fmac_f32 v166, v169, v225
    v_fmac_f32 v166, v170, v226
    v_fmac_f32 v166, v171, v227
    v_accvgpr_read_b32 v168, a124
    v_accvgpr_read_b32 v169, a125
    v_accvgpr_read_b32 v170, a126
    v_accvgpr_read_b32 v171, a127
    v_fmac_f32 v167, v168, v224
    v_fmac_f32 v167, v169, v225
    v_fmac_f32 v167, v170, v226
    v_fmac_f32 v167, v171, v227
    v_mov_b32 v176, v160
    v_mov_b32 v177, v161
    v_mov_b32 v178, v162
    v_mov_b32 v179, v163
    v_mov_b32 v180, v164
    v_mov_b32 v181, v165
    v_mov_b32 v182, v166
    v_mov_b32 v183, v167
    s_nop 1
    v_permlane16_swap_b32 v160, v176
    v_permlane16_swap_b32 v161, v177
    v_permlane16_swap_b32 v162, v178
    v_permlane16_swap_b32 v163, v179
    v_permlane16_swap_b32 v164, v180
    v_permlane16_swap_b32 v165, v181
    v_permlane16_swap_b32 v166, v182
    v_permlane16_swap_b32 v167, v183
    v_add_f32 v160, v160, v176
    v_add_f32 v161, v161, v177
    v_add_f32 v162, v162, v178
    v_add_f32 v163, v163, v179
    v_add_f32 v164, v164, v180
    v_add_f32 v165, v165, v181
    v_add_f32 v166, v166, v182
    v_add_f32 v167, v167, v183
    v_mov_b32 v176, v160
    v_mov_b32 v177, v161
    v_mov_b32 v178, v162
    v_mov_b32 v179, v163
    v_mov_b32 v180, v164
    v_mov_b32 v181, v165
    v_mov_b32 v182, v166
    v_mov_b32 v183, v167
    s_nop 1
    v_permlane32_swap_b32 v160, v176
    v_permlane32_swap_b32 v161, v177
    v_permlane32_swap_b32 v162, v178
    v_permlane32_swap_b32 v163, v179
    v_permlane32_swap_b32 v164, v180
    v_permlane32_swap_b32 v165, v181
    v_permlane32_swap_b32 v166, v182
    v_permlane32_swap_b32 v167, v183
    v_add_f32 v160, v160, v176
    v_add_f32 v161, v161, v177
    v_add_f32 v162, v162, v178
    v_add_f32 v163, v163, v179
    v_add_f32 v164, v164, v180
    v_add_f32 v165, v165, v181
    v_add_f32 v166, v166, v182
    v_add_f32 v167, v167, v183
    v_cmp_eq_u32 vcc, 1, v2
    s_nop 1
    v_cndmask_b32 v184, v160, v164, vcc
    v_cndmask_b32 v185, v161, v165, vcc
    v_cndmask_b32 v186, v162, v166, vcc
    v_cndmask_b32 v187, v163, v167, vcc
    s_lshl_b32 s57, s75, 9
    s_add_u32 s57, s57, s67
    s_mov_b32 exec_lo, -1
    s_mov_b32 exec_hi, 0
    buffer_store_dwordx4 v[184:187], v228, s[20:23], s57 offen sc1
    s_waitcnt vmcnt(0)
    s_mov_b64 exec, 1
    v_mov_b32 v12, 1
    buffer_atomic_add v12, v10, s[20:23], s69 offen sc0
    s_waitcnt vmcnt(0)
    v_readfirstlane_b32 s57, v12
    s_mov_b64 exec, -1
    s_cmp_lg_u32 s57, 15
    s_cbranch_scc1 L_end
    buffer_load_dwordx4 v[160:163], v229, s[20:23], s67 offen offset:0 sc1
    buffer_load_dwordx4 v[164:167], v229, s[20:23], s67 offen offset:1024 sc1
    buffer_load_dwordx4 v[168:171], v229, s[20:23], s67 offen offset:2048 sc1
    buffer_load_dwordx4 v[172:175], v229, s[20:23], s67 offen offset:3072 sc1
    buffer_load_dwordx4 v[176:179], v229, s[20:23], s68 offen offset:0 sc1
    buffer_load_dwordx4 v[180:183], v229, s[20:23], s68 offen offset:1024 sc1
    buffer_load_dwordx4 v[184:187], v229, s[20:23], s68 offen offset:2048 sc1
    buffer_load_dwordx4 v[188:191], v229, s[20:23], s68 offen offset:3072 sc1
    s_waitcnt vmcnt(0)
    v_add_f32 v160, v160, v164
    v_add_f32 v161, v161, v165
    v_add_f32 v162, v162, v166
    v_add_f32 v163, v163, v167
    v_add_f32 v160, v160, v168
    v_add_f32 v161, v161, v169
    v_add_f32 v162, v162, v170
    v_add_f32 v163, v163, v171
    v_add_f32 v160, v160, v172
    v_add_f32 v161, v161, v173
    v_add_f32 v162, v162, v174
    v_add_f32 v163, v163, v175
    v_add_f32 v160, v160, v176
    v_add_f32 v161, v161, v177
    v_add_f32 v162, v162, v178
    v_add_f32 v163, v163, v179
    v_add_f32 v160, v160, v180
    v_add_f32 v161, v161, v181
    v_add_f32 v162, v162, v182
    v_add_f32 v163, v163, v183
    v_add_f32 v160, v160, v184
    v_add_f32 v161, v161, v185
    v_add_f32 v162, v162, v186
    v_add_f32 v163, v163, v187
    v_add_f32 v160, v160, v188
    v_add_f32 v161, v161, v189
    v_add_f32 v162, v162, v190
    v_add_f32 v163, v163, v191
    v_mov_b32 v164, v160
    v_mov_b32 v165, v161
    v_mov_b32 v166, v162
    v_mov_b32 v167, v163
    s_nop 1
    v_permlane32_swap_b32 v160, v164
    v_permlane32_swap_b32 v161, v165
    v_permlane32_swap_b32 v162, v166
    v_permlane32_swap_b32 v163, v167
    v_add_f32 v160, v160, v164
    v_add_f32 v161, v161, v165
    v_add_f32 v162, v162, v166
    v_add_f32 v163, v163, v167
    v_cvt_pk_bf16_f32 v168, v160, v161
    v_cvt_pk_bf16_f32 v169, v162, v163
    s_mov_b32 exec_lo, -1
    s_mov_b32 exec_hi, 0
    buffer_store_dwordx2 v[168:169], v230, s[28:31], 0 offen
L_end:
    s_endpgm
.section .rodata,"a"
.p2align 6
.amdhsa_kernel standalone__low_rank_proj_linformer__decode_kernel
  .amdhsa_next_free_vgpr 424
  .amdhsa_next_free_sgpr 102
  .amdhsa_accum_offset 232
  .amdhsa_group_segment_fixed_size 0
  .amdhsa_kernarg_size 64
  .amdhsa_user_sgpr_count 2
  .amdhsa_user_sgpr_kernarg_segment_ptr 1
  .amdhsa_system_sgpr_workgroup_id_x 1
.end_amdhsa_kernel
```
